```python
import torch

def _softmax(x, axis=-1):
    return torch.softmax(x, dim=axis)
def _gelu(x):
    return torch.nn.functional.gelu(x, approximate="tanh")
def _silu(x):
    return torch.nn.functional.silu(x)
def _sigmoid(x):
    return torch.sigmoid(x)
def _layernorm(x, axis=-1, eps=1e-5):
    m = x.mean(dim=axis, keepdim=True)
    v = x.var(dim=axis, keepdim=True, unbiased=False)
    return (x - m) / torch.sqrt(v + eps)
def _scatter_add(tgt, idx, src, axis=0):
    return tgt.clone().index_add_(axis, idx, src)
def _segment_sum(src, seg, n):
    out = torch.zeros((n,) + src.shape[1:], dtype=src.dtype)
    return out.index_add_(0, seg, src)
def _pad(x, pw):
    flat = tuple(v for pair in reversed(pw) for v in pair)
    return torch.nn.functional.pad(x, flat)

kernel_name = 'parallel_sum__ssm_conv_h3__dense_activation_silu__prompt'

def setup_inputs():

    _w = (lambda a: (lambda t: t.to(torch.bfloat16) if t.is_floating_point() else t)(torch.as_tensor(a)))
    def _A_setup():
        B, S, D = 1, 2048, 1024
        ks = 4
        return {
            "q": _w((lambda *s: torch.randn(*s, dtype=torch.bfloat16) * 0.05)(B, S, D)),
            "k": _w((lambda *s: torch.randn(*s, dtype=torch.bfloat16) * 0.2)(B, S, D)),
            "v": _w((lambda *s: torch.randn(*s, dtype=torch.bfloat16) * 0.2)(B, S, D)),
            "shift_k": _w((lambda *s: torch.randn(*s, dtype=torch.bfloat16) * 0.2)(D, ks) * 0.5),
            "ssm_k": _w((lambda *s: torch.randn(*s, dtype=torch.bfloat16) * 0.4)(D, S) * (1.0 / S ** 0.5)),
            "ssm_D": _w((lambda *s: torch.randn(*s, dtype=torch.bfloat16) * 0.2)(D)),
        }
    _A_in = _A_setup()

    def _B_setup():
        B, S, D, F = 1, 2048, 1024, 3584
        return {
            "x": _w((lambda *s: torch.randn(*s, dtype=torch.bfloat16) * 0.05)(B, S, D)),
            "w1": _w((lambda *s: torch.randn(*s, dtype=torch.bfloat16) * 0.8)(D, F) * (D ** -0.5)),
            "w2": _w((lambda *s: torch.randn(*s, dtype=torch.bfloat16) * 0.1)(F, D) * (F ** -0.5)),
        }
    _B_in = _B_setup()

    return {
        "A_q": _A_in["q"],
        "A_k": _A_in["k"],
        "A_v": _A_in["v"],
        "A_shift_k": _A_in["shift_k"],
        "A_ssm_k": _A_in["ssm_k"],
        "A_ssm_D": _A_in["ssm_D"],
        "B_x": _B_in["x"],
        "B_w1": _B_in["w1"],
        "B_w2": _B_in["w2"],
    }

def reference(A_q, A_k, A_v, A_shift_k, A_ssm_k, A_ssm_D, B_x, B_w1, B_w2):
    def _A_ref(q, k, v, shift_k, ssm_k, ssm_D):
        B, S, D = q.shape
        ks = shift_k.shape[-1]
        k_pad = _pad(k, ((0, 0), (ks - 1, 0), (0, 0)))
        k_shift = torch.zeros_like(k)
        for t in range(ks):
            k_shift = k_shift + k_pad[:, t:t + S, :] * shift_k[:, ks - 1 - t][None, None, :]
        kv = k_shift * v
        L = 2 * S
        kv_pad = _pad(kv, ((0, 0), (0, S), (0, 0)))
        kf_pad = _pad(ssm_k, ((0, 0), (0, S)))
        kv_f = (lambda x, axes=(-2,-1): torch.fft.rfft2(x.float(), dim=axes))(kv_pad[:, None, :, :], axes=(1, 2))
        kf_f = (lambda x, axes=(-2,-1): torch.fft.rfft2(x.float(), dim=axes))(kf_pad[:, None, :], axes=(1, 2))
        kf_f = (lambda x, *d: x.permute(*d))(kf_f, 1, 2, 0)
        y_f = kv_f * kf_f[None, :, :, :]
        y = (lambda x, s, axes=(-2,-1): torch.fft.irfft2(x, s=s, dim=axes).to(torch.bfloat16))(y_f, (1, L), axes=(1, 2))[:, 0, :S, :]
        y = y + kv * ssm_D[None, None, :]
        return q * y

    def _B_ref(x, w1, w2):
        h = torch.einsum("bsd,df->bsf", x, w1)
        h = _silu(h)
        out = torch.einsum("bsf,fd->bsd", h, w2)
        return out

    x = A_q
    xn = _layernorm(x, axis=-1)
    return x + _A_ref(xn, A_k, A_v, A_shift_k, A_ssm_k, A_ssm_D) + _B_ref(xn, B_w1, B_w2)
```

```asm
; @launch grid=(256,1,1) block=(512,1,1) lds=163840
.amdgcn_target "amdgcn-amd-amdhsa--gfx950"
.text
.globl parallel_sum__ssm_conv_h3__dense_activation_silu__prompt_kernel
.p2align 8
.type parallel_sum__ssm_conv_h3__dense_activation_silu__prompt_kernel,@function
parallel_sum__ssm_conv_h3__dense_activation_silu__prompt_kernel:
K_begin:
    s_cmp_ge_u32 s2, 256
    s_cbranch_scc1 K_end
    s_load_dwordx16 s[8:23], s[0:1], 0
    s_load_dwordx8 s[24:31], s[0:1], 64
    s_getpc_b64 s[56:57]
K_pc:
    v_lshlrev_b32 v239, 6, v0
    v_min_u32 v239, K_end-K_pc-4, v239
    global_load_dword v239, v239, s[56:57]
    v_lshrrev_b32 v1, 6, v0
    v_and_b32 v2, 63, v0
    s_and_b32 s4, s2, 1
    v_readfirstlane_b32 s3, v1
    s_lshl_b32 s4, s4, 3
    s_bfe_u32 s6, s2, 0x30003
    s_add_u32 s4, s4, s6
    s_lshr_b32 s5, s2, 6
    s_lshl_b32 s5, s5, 2
    s_bfe_u32 s6, s2, 0x20001
    s_add_u32 s5, s5, s6
    s_lshl_b32 s6, s4, 4
    s_add_u32 s6, s6, s5
    s_cmp_lt_u32 s3, 4
    s_cbranch_scc1 C_start
    s_sub_u32 s3, s3, 4
    v_lshrrev_b32 v3, 3, v2
    v_lshrrev_b32 v4, 4, v2
    v_xor_b32 v4, v4, v2
    v_and_b32 v4, 7, v4
    v_lshlrev_b32 v3, 11, v3
    v_lshl_add_u32 v200, v4, 4, v3
    v_xor_b32 v201, 64, v200
    v_add_u32 v202, 30720, v200
    v_add_u32 v203, 46080, v201
    v_add_u32 v201, 15360, v201
    s_lshl_b32 s48, s4, 18
    s_lshl_b32 s52, s3, 16
    s_add_u32 s48, s48, s52
    s_mul_i32 s49, s5, 448
    s_mul_i32 s52, s3, 114688
    s_add_u32 s49, s49, s52
    s_and_b32 s7, s4, 12
    s_lshl_b32 s52, s7, 7
    s_add_u32 s59, s48, s52
    s_mul_i32 s52, s7, 458752
    s_add_u32 s49, s49, s52
    s_lshl_b32 s50, s3, 12
    s_waitcnt lgkmcnt(0)
    s_mov_b32 s32, s8
    s_and_b32 s33, s9, 0xffff
    s_mov_b32 s34, 4194304
    s_mov_b32 s35, 0x20000
    s_add_u32 m0, s50, 45056
    s_nop 0
    buffer_load_dwordx4 v200, s[32:35], s59 offen offset:0 lds
    buffer_load_dwordx4 v201, s[32:35], s59 offen offset:1024 lds
    buffer_load_dwordx4 v202, s[32:35], s59 offen offset:2048 lds
    buffer_load_dwordx4 v203, s[32:35], s59 offen offset:3072 lds
    v_add_u32 v3, 0, v2
    v_mul_u32_u24 v4, 2341, v3
    v_lshrrev_b32 v4, 16, v4
    v_mul_u32_u24 v5, 6720, v4
    v_lshrrev_b32 v6, 2, v4
    v_and_b32 v6, 2, v6
    v_xor_b32 v3, v3, v6
    v_lshl_add_u32 v204, v3, 4, v5
    v_add_u32 v3, 64, v2
    v_mul_u32_u24 v4, 2341, v3
    v_lshrrev_b32 v4, 16, v4
    v_mul_u32_u24 v5, 6720, v4
    v_lshrrev_b32 v6, 2, v4
    v_and_b32 v6, 2, v6
    v_xor_b32 v3, v3, v6
    v_lshl_add_u32 v205, v3, 4, v5
    v_subrev_u32 v205, 1024, v205
    v_add_u32 v3, 128, v2
    v_mul_u32_u24 v4, 2341, v3
    v_lshrrev_b32 v4, 16, v4
    v_mul_u32_u24 v5, 6720, v4
    v_lshrrev_b32 v6, 2, v4
    v_and_b32 v6, 2, v6
    v_xor_b32 v3, v3, v6
    v_lshl_add_u32 v206, v3, 4, v5
    v_subrev_u32 v206, 2048, v206
    v_add_u32 v3, 192, v2
    v_mul_u32_u24 v4, 2341, v3
    v_lshrrev_b32 v4, 16, v4
    v_mul_u32_u24 v5, 6720, v4
    v_lshrrev_b32 v6, 2, v4
    v_and_b32 v6, 2, v6
    v_xor_b32 v3, v3, v6
    v_lshl_add_u32 v207, v3, 4, v5
    v_subrev_u32 v207, 3072, v207
    v_add_u32 v3, 256, v2
    v_mul_u32_u24 v4, 2341, v3
    v_lshrrev_b32 v4, 16, v4
    v_mul_u32_u24 v5, 6720, v4
    v_lshrrev_b32 v6, 2, v4
    v_and_b32 v6, 2, v6
    v_xor_b32 v3, v3, v6
    v_lshl_add_u32 v208, v3, 4, v5
    v_add_u32 v3, 320, v2
    v_mul_u32_u24 v4, 2341, v3
    v_lshrrev_b32 v4, 16, v4
    v_mul_u32_u24 v5, 6720, v4
    v_lshrrev_b32 v6, 2, v4
    v_and_b32 v6, 2, v6
    v_xor_b32 v3, v3, v6
    v_lshl_add_u32 v209, v3, 4, v5
    v_subrev_u32 v209, 1024, v209
    v_add_u32 v3, 384, v2
    v_mul_u32_u24 v4, 2341, v3
    v_lshrrev_b32 v4, 16, v4
    v_mul_u32_u24 v5, 6720, v4
    v_lshrrev_b32 v6, 2, v4
    v_and_b32 v6, 2, v6
    v_xor_b32 v3, v3, v6
    v_lshl_add_u32 v210, v3, 4, v5
    v_subrev_u32 v210, 2048, v210
    s_lshl_b32 s50, s3, 12
    s_mul_i32 s51, s3, 7168
    s_lshl_b32 s62, s6, 2
    s_add_u32 s62, s62, s3
    s_mov_b32 s1, s59
    s_waitcnt lgkmcnt(0)
    s_mov_b32 s32, s8
    s_and_b32 s33, s9, 0xffff
    s_mov_b32 s34, 4194304
    s_mov_b32 s35, 0x20000
    s_mov_b32 s36, s22
    s_and_b32 s37, s23, 0xffff
    s_mov_b32 s38, 7340032
    s_mov_b32 s39, 0x20000
    s_mov_b32 s40, s30
    s_and_b32 s41, s31, 0xffff
    s_mov_b32 s42, 268435456
    s_mov_b32 s43, 0x20000
    s_add_u32 m0, s51, 61440
    s_add_u32 s60, s49, 0
    buffer_load_dwordx4 v204, s[36:39], s60 offen offset:0  lds
    buffer_load_dwordx4 v205, s[36:39], s60 offen offset:1024  lds
    buffer_load_dwordx4 v206, s[36:39], s60 offen offset:2048  lds
    buffer_load_dwordx4 v207, s[36:39], s60 offen offset:3072  lds
    s_add_u32 m0, s51, 65536
    s_nop 0
    buffer_load_dwordx4 v208, s[36:39], s60 offen offset:0  lds
    buffer_load_dwordx4 v209, s[36:39], s60 offen offset:1024  lds
    buffer_load_dwordx4 v210, s[36:39], s60 offen offset:2048  lds
    s_add_u32 m0, s50, 90112
    s_add_u32 s20, s1, 128
    buffer_load_dwordx4 v200, s[32:35], s20 offen offset:0  lds
    s_mov_b32 s44, s18
    s_and_b32 s45, s19, 0xffff
    s_mov_b32 s46, 2048
    s_mov_b32 s47, 0x20000
    s_lshl_b32 s52, s62, 1
    v_mov_b32 v221, 0
    buffer_load_ushort v232, v221, s[44:47], s52 offen
    s_mov_b32 s44, s16
    s_and_b32 s45, s17, 0xffff
    s_mov_b32 s46, 4194304
    s_mov_b32 s47, 0x20000
    s_lshl_b32 s52, s62, 12
    buffer_load_ushort v233, v221, s[44:47], s52 offen
    v_lshrrev_b32 v8, 4, v2
    v_and_b32 v7, 15, v2
    v_lshrrev_b32 v5, 2, v7
    v_lshl_add_u32 v5, v8, 3, v5
    v_mul_u32_u24 v5, 448, v5
    v_and_b32 v6, 3, v2
    v_lshl_add_u32 v5, v6, 3, v5
    v_and_b32 v6, 1, v8
    v_xor_b32 v6, s3, v6
    buffer_load_dwordx4 v201, s[32:35], s20 offen offset:1024  lds
    v_lshl_add_u32 v5, v6, 5, v5
    v_add_u32 v30, 16384, v5
    v_lshlrev_b32 v31, 4, v8
    v_lshl_add_u32 v31, v7, 8, v31
    v_mov_b32 v5, 0x3f803f80
    v_cmp_eq_u32 vcc, 0, v7
    s_nop 1
    v_cndmask_b32 v176, 0, v5, vcc
    v_mov_b32 v177, v176
    v_mov_b32 v178, v176
    v_mov_b32 v179, v176
    v_cmp_eq_u32 vcc, 1, v7
    s_nop 1
    v_cndmask_b32 v180, 0, v5, vcc
    v_mov_b32 v181, v180
    v_mov_b32 v182, v180
    v_mov_b32 v183, v180
    v_cmp_eq_u32 vcc, 2, v7
    s_nop 1
    v_cndmask_b32 v184, 0, v5, vcc
    v_mov_b32 v185, v184
    v_mov_b32 v186, v184
    v_mov_b32 v187, v184
    v_cmp_eq_u32 vcc, 3, v7
    s_nop 1
    v_cndmask_b32 v188, 0, v5, vcc
    v_mov_b32 v189, v188
    v_mov_b32 v190, v188
    v_mov_b32 v191, v188
    s_lshl_b32 s52, s4, 4
    v_add_u32 v4, s52, v7
    buffer_load_dwordx4 v202, s[32:35], s20 offen offset:2048  lds
    v_lshlrev_b32 v3, 4, v7
    v_add_u32 v3, s5, v3
    v_cmp_gt_u32 vcc, 16, v2
    v_lshlrev_b32 v26, 2, v2
    v_lshlrev_b32 v234, 2, v2
    v_lshlrev_b32 v235, 9, v2
    s_mul_i32 s52, s3, 224
    v_cndmask_b32 v27, v3, v4, vcc
    v_lshlrev_b32 v27, 7, v27
    v_add_u32 v18, s52, v26
    v_lshlrev_b32 v212, 4, v2
    buffer_load_dwordx4 v203, s[32:35], s20 offen offset:3072  lds
    v_add_u32 v213, 112640, v212
    v_lshlrev_b32 v219, 7, v2
    s_lshr_b32 s52, s62, 6
    s_mul_i32 s52, s52, 458752
    s_and_b32 s53, s62, 63
    s_lshl_b32 s53, s53, 10
    s_add_u32 s52, s52, s53
    s_add_u32 s18, s24, s52
    s_addc_u32 s19, s25, 0
    v_lshrrev_b32 v8, 4, v2
    v_and_b32 v7, 15, v2
    s_add_u32 m0, s51, 106496
    s_add_u32 s60, s49, 458752
    buffer_load_dwordx4 v204, s[36:39], s60 offen offset:0  lds
    s_and_b32 s61, s6, 31
    s_lshl_b32 s52, s61, 17
    s_lshr_b32 s53, s6, 5
    s_lshl_b32 s53, s53, 2
    s_add_u32 s53, s53, s3
    s_lshl_b32 s54, s53, 6
    s_add_u32 s54, s54, s52
    v_and_b32 v5, 3, v2
    v_lshlrev_b32 v5, 4, v5
    v_add_u32 v5, s54, v5
    v_lshrrev_b32 v6, 2, v2
    buffer_load_dwordx4 v205, s[36:39], s60 offen offset:1024  lds
    v_add_u32 v3, 0, v6
    v_mul_u32_u24 v4, 57, v3
    v_lshrrev_b32 v4, 9, v4
    v_mul_u32_u24 v80, 71, v4
    v_lshlrev_b32 v3, 3, v3
    v_sub_u32 v3, v3, v80
    v_lshl_add_u32 v80, v3, 11, v5
    v_subrev_u32 v80, 16384, v80
    v_add_u32 v3, 16, v6
    v_mul_u32_u24 v4, 57, v3
    v_lshrrev_b32 v4, 9, v4
    buffer_load_dwordx4 v206, s[36:39], s60 offen offset:2048  lds
    v_mul_u32_u24 v81, 71, v4
    v_lshlrev_b32 v3, 3, v3
    v_sub_u32 v3, v3, v81
    v_lshl_add_u32 v81, v3, 11, v5
    v_subrev_u32 v81, 17408, v81
    v_add_u32 v3, 32, v6
    v_mul_u32_u24 v4, 57, v3
    v_lshrrev_b32 v4, 9, v4
    v_mul_u32_u24 v82, 71, v4
    v_lshlrev_b32 v3, 3, v3
    v_sub_u32 v3, v3, v82
    buffer_load_dwordx4 v207, s[36:39], s60 offen offset:3072  lds
    v_lshl_add_u32 v82, v3, 11, v5
    v_subrev_u32 v82, 18432, v82
    v_add_u32 v3, 48, v6
    v_mul_u32_u24 v4, 57, v3
    v_lshrrev_b32 v4, 9, v4
    v_mul_u32_u24 v83, 71, v4
    v_lshlrev_b32 v3, 3, v3
    v_sub_u32 v3, v3, v83
    v_lshl_add_u32 v83, v3, 11, v5
    v_subrev_u32 v83, 19456, v83
    s_add_u32 m0, s51, 110592
    s_nop 0
    buffer_load_dwordx4 v208, s[36:39], s60 offen offset:0  lds
    v_add_u32 v3, 64, v6
    v_mul_u32_u24 v4, 57, v3
    v_lshrrev_b32 v4, 9, v4
    v_mul_u32_u24 v84, 71, v4
    v_lshlrev_b32 v3, 3, v3
    v_sub_u32 v3, v3, v84
    v_lshl_add_u32 v84, v3, 11, v5
    v_subrev_u32 v84, 16384, v84
    v_and_b32 v3, 7, v6
    v_lshrrev_b32 v4, 3, v6
    v_lshl_add_u32 v3, v3, 3, v4
    buffer_load_dwordx4 v209, s[36:39], s60 offen offset:1024  lds
    v_lshl_add_u32 v85, v3, 11, v5
    v_and_b32 v3, 7, v2
    v_lshrrev_b32 v4, 3, v2
    s_lshl_b32 s52, s53, 8
    v_lshlrev_b32 v24, 5, v4
    v_add_u32 v24, s52, v24
    v_lshlrev_b32 v22, 6, v3
    v_lshl_add_u32 v22, v4, 3, v22
    v_add_u32 v23, s51, v22
    v_add_u32 v23, 135168, v23
    v_mov_b32 v22, v85
    buffer_load_dwordx4 v210, s[36:39], s60 offen offset:2048  lds
    s_mov_b32 s56, 4096
    s_mov_b32 s57, 8192
    s_mov_b32 s58, 12288
    s_lshl_b32 s54, s53, 17
    s_lshl_b32 s52, s61, 7
    s_sub_u32 s54, s54, s52
    s_add_u32 s54, s54, 4198384
    v_lshlrev_b32 v25, 14, v4
    v_lshlrev_b32 v3, 4, v3
    v_sub_u32 v25, v25, v3
    v_add_u32 v25, s54, v25
    s_waitcnt vmcnt(13)
    s_barrier
    s_add_u32 m0, s50, 0
    s_add_u32 s20, s1, 256
    buffer_load_dwordx4 v200, s[32:35], s20 offen offset:0  lds
    buffer_load_dwordx4 v201, s[32:35], s20 offen offset:1024  lds
    buffer_load_dwordx4 v202, s[32:35], s20 offen offset:2048  lds
    buffer_load_dwordx4 v203, s[32:35], s20 offen offset:3072  lds
    s_add_u32 m0, s51, 16384
    s_add_u32 s60, s49, 917504
    buffer_load_dwordx4 v204, s[36:39], s60 offen offset:0  lds
    buffer_load_dwordx4 v205, s[36:39], s60 offen offset:1024  lds
    buffer_load_dwordx4 v206, s[36:39], s60 offen offset:2048  lds
    buffer_load_dwordx4 v207, s[36:39], s60 offen offset:3072  lds
    s_add_u32 m0, s51, 20480
    s_nop 0
    buffer_load_dwordx4 v208, s[36:39], s60 offen offset:0  lds
    buffer_load_dwordx4 v209, s[36:39], s60 offen offset:1024  lds
    buffer_load_dwordx4 v210, s[36:39], s60 offen offset:2048  lds
    s_and_b32 s52, s4, 3
    s_cmp_lg_u32 s52, 0
    s_cbranch_scc1 CD4
    v_add_u32 v30, 45056, v30
    s_cmp_ge_u32 s3, 2
    s_cselect_b32 s52, 128, 0
    v_subrev_u32 v236, s52, v30
    ds_read_b64_tr_b16 v[112:113], v30 offset:0
    ds_read_b64_tr_b16 v[114:115], v30 offset:1792
    ds_read_b64_tr_b16 v[116:117], v30 offset:14336
    ds_read_b64_tr_b16 v[118:119], v30 offset:16128
    ds_read_b64_tr_b16 v[120:121], v30 offset:128
    ds_read_b64_tr_b16 v[122:123], v30 offset:1920
    ds_read_b64_tr_b16 v[124:125], v30 offset:14464
    ds_read_b64_tr_b16 v[126:127], v30 offset:16256
    ds_read_b64_tr_b16 v[128:129], v30 offset:256
    ds_read_b64_tr_b16 v[130:131], v30 offset:2048
    ds_read_b64_tr_b16 v[132:133], v30 offset:14592
    ds_read_b64_tr_b16 v[134:135], v30 offset:16384
    ds_read_b64_tr_b16 v[136:137], v236 offset:384
    ds_read_b64_tr_b16 v[138:139], v236 offset:2176
    ds_read_b64_tr_b16 v[140:141], v236 offset:14720
    ds_read_b64_tr_b16 v[142:143], v236 offset:16512
    s_waitcnt lgkmcnt(0)
CD4:
    s_waitcnt vmcnt(11)
    s_barrier
    s_add_u32 m0, s50, 45056
    s_add_u32 s20, s1, 384
    buffer_load_dwordx4 v200, s[32:35], s20 offen offset:0  lds
    buffer_load_dwordx4 v201, s[32:35], s20 offen offset:1024  lds
    buffer_load_dwordx4 v202, s[32:35], s20 offen offset:2048  lds
    buffer_load_dwordx4 v203, s[32:35], s20 offen offset:3072  lds
    s_add_u32 m0, s51, 61440
    s_add_u32 s60, s49, 1376256
    buffer_load_dwordx4 v204, s[36:39], s60 offen offset:0  lds
    buffer_load_dwordx4 v205, s[36:39], s60 offen offset:1024  lds
    buffer_load_dwordx4 v206, s[36:39], s60 offen offset:2048  lds
    buffer_load_dwordx4 v207, s[36:39], s60 offen offset:3072  lds
    s_add_u32 m0, s51, 65536
    s_nop 0
    buffer_load_dwordx4 v208, s[36:39], s60 offen offset:0  lds
    buffer_load_dwordx4 v209, s[36:39], s60 offen offset:1024  lds
    buffer_load_dwordx4 v210, s[36:39], s60 offen offset:2048  lds
    s_and_b32 s52, s4, 3
    s_cmp_lg_u32 s52, 1
    s_cbranch_scc1 CD5
    v_add_u32 v30, 90112, v30
    s_cmp_ge_u32 s3, 2
    s_cselect_b32 s52, 128, 0
    v_subrev_u32 v236, s52, v30
    ds_read_b64_tr_b16 v[112:113], v30 offset:0
    ds_read_b64_tr_b16 v[114:115], v30 offset:1792
    ds_read_b64_tr_b16 v[116:117], v30 offset:14336
    ds_read_b64_tr_b16 v[118:119], v30 offset:16128
    ds_read_b64_tr_b16 v[120:121], v30 offset:128
    ds_read_b64_tr_b16 v[122:123], v30 offset:1920
    ds_read_b64_tr_b16 v[124:125], v30 offset:14464
    ds_read_b64_tr_b16 v[126:127], v30 offset:16256
    ds_read_b64_tr_b16 v[128:129], v30 offset:256
    ds_read_b64_tr_b16 v[130:131], v30 offset:2048
    ds_read_b64_tr_b16 v[132:133], v30 offset:14592
    ds_read_b64_tr_b16 v[134:135], v30 offset:16384
    ds_read_b64_tr_b16 v[136:137], v236 offset:384
    ds_read_b64_tr_b16 v[138:139], v236 offset:2176
    ds_read_b64_tr_b16 v[140:141], v236 offset:14720
    ds_read_b64_tr_b16 v[142:143], v236 offset:16512
    s_waitcnt lgkmcnt(0)
CD5:
    s_waitcnt vmcnt(11)
    s_barrier
    s_cmp_eq_u32 s7, 12
    s_cselect_b32 s20, 2048, 0
    s_cselect_b32 s60, 7340032, 0
    s_sub_u32 s1, s1, s20
    s_sub_u32 s49, s49, s60
    s_add_u32 m0, s50, 90112
    s_add_u32 s20, s1, 512
    buffer_load_dwordx4 v200, s[32:35], s20 offen offset:0  lds
    buffer_load_dwordx4 v201, s[32:35], s20 offen offset:1024  lds
    buffer_load_dwordx4 v202, s[32:35], s20 offen offset:2048  lds
    buffer_load_dwordx4 v203, s[32:35], s20 offen offset:3072  lds
    s_add_u32 m0, s51, 106496
    s_add_u32 s60, s49, 1835008
    buffer_load_dwordx4 v204, s[36:39], s60 offen offset:0  lds
    buffer_load_dwordx4 v205, s[36:39], s60 offen offset:1024  lds
    buffer_load_dwordx4 v206, s[36:39], s60 offen offset:2048  lds
    buffer_load_dwordx4 v207, s[36:39], s60 offen offset:3072  lds
    s_add_u32 m0, s51, 110592
    s_nop 0
    buffer_load_dwordx4 v208, s[36:39], s60 offen offset:0  lds
    buffer_load_dwordx4 v209, s[36:39], s60 offen offset:1024  lds
    buffer_load_dwordx4 v210, s[36:39], s60 offen offset:2048  lds
    s_mov_b32 s44, s10
    s_and_b32 s45, s11, 0xffff
    s_mov_b32 s46, 4194304
    s_mov_b32 s47, 0x20000
    s_add_u32 m0, s51, 135168
    s_nop 0
    buffer_load_dwordx4 v80, s[44:47], 0 offen offset:0 lds
    buffer_load_dwordx4 v81, s[44:47], 0 offen offset:1024 lds
    buffer_load_dwordx4 v82, s[44:47], 0 offen offset:2048 lds
    buffer_load_dwordx4 v83, s[44:47], 0 offen offset:3072 lds
    s_add_u32 m0, s51, 139264
    s_mov_b32 exec_hi, 0
    buffer_load_dwordx4 v84, s[44:47], 0 offen lds
    s_mov_b32 exec_hi, -1
    s_mov_b32 s44, s14
    s_and_b32 s45, s15, 0xffff
    s_mov_b32 s46, 8192
    s_mov_b32 s47, 0x20000
    buffer_load_dwordx4 v[72:75], v24, s[44:47], 0 offen
    buffer_load_dwordx4 v[76:79], v24, s[44:47], 0 offen offset:16
    s_and_b32 s52, s4, 3
    s_cmp_lg_u32 s52, 2
    s_cbranch_scc1 CD6
    v_add_u32 v30, 0, v30
    s_cmp_ge_u32 s3, 2
    s_cselect_b32 s52, 128, 0
    v_subrev_u32 v236, s52, v30
    ds_read_b64_tr_b16 v[112:113], v30 offset:0
    ds_read_b64_tr_b16 v[114:115], v30 offset:1792
    ds_read_b64_tr_b16 v[116:117], v30 offset:14336
    ds_read_b64_tr_b16 v[118:119], v30 offset:16128
    ds_read_b64_tr_b16 v[120:121], v30 offset:128
    ds_read_b64_tr_b16 v[122:123], v30 offset:1920
    ds_read_b64_tr_b16 v[124:125], v30 offset:14464
    ds_read_b64_tr_b16 v[126:127], v30 offset:16256
    ds_read_b64_tr_b16 v[128:129], v30 offset:256
    ds_read_b64_tr_b16 v[130:131], v30 offset:2048
    ds_read_b64_tr_b16 v[132:133], v30 offset:14592
    ds_read_b64_tr_b16 v[134:135], v30 offset:16384
    ds_read_b64_tr_b16 v[136:137], v236 offset:384
    ds_read_b64_tr_b16 v[138:139], v236 offset:2176
    ds_read_b64_tr_b16 v[140:141], v236 offset:14720
    ds_read_b64_tr_b16 v[142:143], v236 offset:16512
    s_waitcnt lgkmcnt(0)
CD6:
    s_waitcnt vmcnt(18)
    s_barrier
L_join:
    s_add_u32 m0, s50, 0
    s_add_u32 s20, s1, 640
    buffer_load_dwordx4 v200, s[32:35], s20 offen offset:0  lds
    buffer_load_dwordx4 v201, s[32:35], s20 offen offset:1024  lds
    buffer_load_dwordx4 v202, s[32:35], s20 offen offset:2048  lds
    buffer_load_dwordx4 v203, s[32:35], s20 offen offset:3072  lds
    s_add_u32 m0, s51, 16384
    s_add_u32 s60, s49, 2293760
    buffer_load_dwordx4 v204, s[36:39], s60 offen offset:0  lds
    buffer_load_dwordx4 v205, s[36:39], s60 offen offset:1024  lds
    buffer_load_dwordx4 v206, s[36:39], s60 offen offset:2048  lds
    buffer_load_dwordx4 v207, s[36:39], s60 offen offset:3072  lds
    s_add_u32 m0, s51, 20480
    s_nop 0
    buffer_load_dwordx4 v208, s[36:39], s60 offen offset:0  lds
    buffer_load_dwordx4 v209, s[36:39], s60 offen offset:1024  lds
    buffer_load_dwordx4 v210, s[36:39], s60 offen offset:2048  lds
    s_and_b32 s52, s4, 3
    s_cmp_lg_u32 s52, 3
    s_cbranch_scc1 CD7
    v_add_u32 v30, 45056, v30
    s_cmp_ge_u32 s3, 2
    s_cselect_b32 s52, 128, 0
    v_subrev_u32 v236, s52, v30
    ds_read_b64_tr_b16 v[112:113], v30 offset:0
    ds_read_b64_tr_b16 v[114:115], v30 offset:1792
    ds_read_b64_tr_b16 v[116:117], v30 offset:14336
    ds_read_b64_tr_b16 v[118:119], v30 offset:16128
    ds_read_b64_tr_b16 v[120:121], v30 offset:128
    ds_read_b64_tr_b16 v[122:123], v30 offset:1920
    ds_read_b64_tr_b16 v[124:125], v30 offset:14464
    ds_read_b64_tr_b16 v[126:127], v30 offset:16256
    ds_read_b64_tr_b16 v[128:129], v30 offset:256
    ds_read_b64_tr_b16 v[130:131], v30 offset:2048
    ds_read_b64_tr_b16 v[132:133], v30 offset:14592
    ds_read_b64_tr_b16 v[134:135], v30 offset:16384
    ds_read_b64_tr_b16 v[136:137], v236 offset:384
    ds_read_b64_tr_b16 v[138:139], v236 offset:2176
    ds_read_b64_tr_b16 v[140:141], v236 offset:14720
    ds_read_b64_tr_b16 v[142:143], v236 offset:16512
    s_waitcnt lgkmcnt(0)
CD7:
    s_mov_b32 s44, s28
    s_and_b32 s45, s29, 0xffff
    s_mov_b32 s46, 256
    s_mov_b32 s47, 0x20000
    buffer_load_dwordx2 v[28:29], v221, s[44:47], 0 offen sc1
    s_waitcnt vmcnt(19)
    s_waitcnt lgkmcnt(0)
    s_barrier
    s_add_u32 m0, s50, 45056
    s_add_u32 s20, s1, 768
    buffer_load_dwordx4 v200, s[32:35], s20 offen offset:0  lds
    buffer_load_dwordx4 v201, s[32:35], s20 offen offset:1024  lds
    buffer_load_dwordx4 v202, s[32:35], s20 offen offset:2048  lds
    buffer_load_dwordx4 v203, s[32:35], s20 offen offset:3072  lds
    s_setprio 3
    v_mfma_f32_16x16x32_bf16 v[228:231], v[112:115], v[176:179], 0
    v_mfma_f32_16x16x32_bf16 v[228:231], v[116:119], v[176:179], v[228:231]
    v_mfma_f32_16x16x32_bf16 v[228:231], v[120:123], v[180:183], v[228:231]
    v_mfma_f32_16x16x32_bf16 v[228:231], v[124:127], v[180:183], v[228:231]
    v_mfma_f32_16x16x32_bf16 v[228:231], v[128:131], v[184:187], v[228:231]
    v_mfma_f32_16x16x32_bf16 v[228:231], v[132:135], v[184:187], v[228:231]
    v_mfma_f32_16x16x32_bf16 v[228:231], v[136:139], v[188:191], v[228:231]
    v_mfma_f32_16x16x32_bf16 v[228:231], v[140:143], v[188:191], v[228:231]
    s_setprio 0
    s_add_u32 m0, s51, 61440
    s_add_u32 s60, s49, 2752512
    buffer_load_dwordx4 v204, s[36:39], s60 offen offset:0  lds
    buffer_load_dwordx4 v205, s[36:39], s60 offen offset:1024  lds
    buffer_load_dwordx4 v206, s[36:39], s60 offen offset:2048  lds
    buffer_load_dwordx4 v207, s[36:39], s60 offen offset:3072  lds
    s_waitcnt vmcnt(20)
    s_add_u32 m0, s51, 65536
    s_nop 0
    buffer_load_dwordx4 v208, s[36:39], s60 offen offset:0  lds
    buffer_load_dwordx4 v209, s[36:39], s60 offen offset:1024  lds
    buffer_load_dwordx4 v210, s[36:39], s60 offen offset:2048  lds
    ds_read_b64 v[32:33], v23 offset:2880
    ds_read_b64 v[34:35], v23 offset:3456
    ds_read_b64 v[36:37], v23 offset:4032
    ds_read_b64 v[38:39], v23 offset:64
    ds_read_b64 v[40:41], v23 offset:640
    ds_read_b64 v[42:43], v23 offset:1216
    ds_read_b64 v[44:45], v23 offset:1792
    ds_read_b64 v[46:47], v23 offset:2368
    ds_read_b64 v[48:49], v23 offset:2944
    ds_read_b64 v[50:51], v23 offset:3520
    ds_read_b64 v[52:53], v23 offset:4096
    s_waitcnt lgkmcnt(0)
    s_mov_b32 s44, s12
    s_and_b32 s45, s13, 0xffff
    s_mov_b32 s46, 4194304
    s_mov_b32 s47, 0x20000
    s_add_u32 m0, s51, 135168
    s_nop 0
    buffer_load_dwordx4 v22, s[44:47], 0 offen lds
    s_add_u32 m0, s51, 136192
    s_nop 0
    buffer_load_dwordx4 v22, s[44:47], s56 offen lds
    s_add_u32 m0, s51, 137216
    s_nop 0
    buffer_load_dwordx4 v22, s[44:47], s57 offen lds
    s_add_u32 m0, s51, 138240
    s_nop 0
    buffer_load_dwordx4 v22, s[44:47], s58 offen lds
    s_lshl_b32 s52, s5, 4
    s_add_u32 s52, s52, s4
    s_lshl_b32 s52, s52, 10
    s_lshl_b32 s53, s3, 6
    s_add_u32 s52, s52, s53
    s_add_u32 s52, s52, 29360128
    s_mov_b32 s54, 0x000f000f
    s_mov_b32 s55, 0x000f000f
    s_nop 1
    s_mov_b64 exec, s[54:55]
    buffer_store_dwordx4 v[228:231], v31, s[40:43], s52 offen sc1
    s_mov_b64 exec, -1
    s_waitcnt vmcnt(17)
    s_barrier
    s_add_u32 m0, s50, 90112
    s_add_u32 s20, s1, 896
    buffer_load_dwordx4 v200, s[32:35], s20 offen offset:0  lds
    v_lshlrev_b32 v92, 16, v72
    v_and_b32 v93, 0xffff0000, v72
    v_lshlrev_b32 v94, 16, v73
    v_and_b32 v95, 0xffff0000, v73
    s_load_dword s2, s[18:19], 0
    v_lshlrev_b32 v80, 16, v32
    buffer_load_dwordx4 v201, s[32:35], s20 offen offset:1024  lds
    v_lshlrev_b32 v81, 16, v34
    v_lshlrev_b32 v82, 16, v36
    s_load_dword s2, s[18:19], 64
    v_lshlrev_b32 v83, 16, v38
    v_lshlrev_b32 v84, 16, v40
    v_lshlrev_b32 v85, 16, v42
    buffer_load_dwordx4 v202, s[32:35], s20 offen offset:2048  lds
    v_lshlrev_b32 v86, 16, v44
    s_load_dword s2, s[18:19], 128
    v_lshlrev_b32 v87, 16, v46
    v_lshlrev_b32 v88, 16, v48
    v_lshlrev_b32 v89, 16, v50
    s_load_dword s2, s[18:19], 192
    v_lshlrev_b32 v90, 16, v52
    buffer_load_dwordx4 v203, s[32:35], s20 offen offset:3072  lds
    v_mul_f32 v96, v95, v80
    v_mul_f32 v97, v95, v81
    s_load_dword s2, s[18:19], 256
    v_mul_f32 v98, v95, v82
    v_mul_f32 v99, v95, v83
    v_mul_f32 v100, v95, v84
    s_add_u32 m0, s51, 106496
    s_add_u32 s60, s49, 3211264
    buffer_load_dwordx4 v204, s[36:39], s60 offen offset:0  lds
    v_mul_f32 v101, v95, v85
    s_load_dword s2, s[18:19], 320
    v_mul_f32 v102, v95, v86
    v_mul_f32 v103, v95, v87
    v_fmac_f32 v96, v94, v81
    s_load_dword s2, s[18:19], 384
    buffer_load_dwordx4 v205, s[36:39], s60 offen offset:1024  lds
    v_fmac_f32 v97, v94, v82
    v_fmac_f32 v98, v94, v83
    v_fmac_f32 v99, v94, v84
    s_load_dword s2, s[18:19], 448
    v_fmac_f32 v100, v94, v85
    v_fmac_f32 v101, v94, v86
    v_fmac_f32 v102, v94, v87
    buffer_load_dwordx4 v206, s[36:39], s60 offen offset:2048  lds
    v_fmac_f32 v103, v94, v88
    s_load_dword s2, s[18:19], 512
    v_fmac_f32 v96, v93, v82
    v_fmac_f32 v97, v93, v83
    v_fmac_f32 v98, v93, v84
    s_load_dword s2, s[18:19], 576
    buffer_load_dwordx4 v207, s[36:39], s60 offen offset:3072  lds
    v_fmac_f32 v99, v93, v85
    v_fmac_f32 v100, v93, v86
    v_fmac_f32 v101, v93, v87
    v_fmac_f32 v102, v93, v88
    s_load_dword s2, s[18:19], 640
    v_fmac_f32 v103, v93, v89
    s_add_u32 m0, s51, 110592
    s_nop 0
    buffer_load_dwordx4 v208, s[36:39], s60 offen offset:0  lds
    v_fmac_f32 v96, v92, v83
    v_fmac_f32 v97, v92, v84
    s_load_dword s2, s[18:19], 704
    v_fmac_f32 v98, v92, v85
    v_fmac_f32 v99, v92, v86
    v_fmac_f32 v100, v92, v87
    s_load_dword s2, s[18:19], 768
    buffer_load_dwordx4 v209, s[36:39], s60 offen offset:1024  lds
    v_fmac_f32 v101, v92, v88
    v_fmac_f32 v102, v92, v89
    v_fmac_f32 v103, v92, v90
    v_lshlrev_b32 v92, 16, v74
    s_load_dword s2, s[18:19], 832
    v_and_b32 v93, 0xffff0000, v74
    buffer_load_dwordx4 v210, s[36:39], s60 offen offset:2048  lds
    v_lshlrev_b32 v94, 16, v75
    v_and_b32 v95, 0xffff0000, v75
    s_load_dword s2, s[18:19], 896
    v_and_b32 v80, 0xffff0000, v32
    v_and_b32 v81, 0xffff0000, v34
    v_and_b32 v82, 0xffff0000, v36
    s_load_dword s2, s[18:19], 960
    s_waitcnt vmcnt(16)
    s_barrier
    s_cmp_eq_u32 s7, 8
    s_cselect_b32 s20, 2048, 0
    s_cselect_b32 s60, 7340032, 0
    s_sub_u32 s1, s1, s20
    s_sub_u32 s49, s49, s60
    s_add_u32 m0, s50, 0
    s_add_u32 s20, s1, 1024
    buffer_load_dwordx4 v200, s[32:35], s20 offen offset:0  lds
    s_waitcnt vmcnt(13)
    ds_read_b64 v[54:55], v23 offset:0
    ds_read_b64 v[56:57], v23 offset:512
    ds_read_b64 v[58:59], v23 offset:1024
    ds_read_b64 v[60:61], v23 offset:1536
    ds_read_b64 v[62:63], v23 offset:2048
    ds_read_b64 v[64:65], v23 offset:2560
    ds_read_b64 v[66:67], v23 offset:3072
    ds_read_b64 v[68:69], v23 offset:3584
    v_and_b32 v83, 0xffff0000, v38
    v_and_b32 v84, 0xffff0000, v40
    v_and_b32 v85, 0xffff0000, v42
    buffer_load_dwordx4 v201, s[32:35], s20 offen offset:1024  lds
    v_and_b32 v86, 0xffff0000, v44
    v_and_b32 v87, 0xffff0000, v46
    v_and_b32 v88, 0xffff0000, v48
    v_and_b32 v89, 0xffff0000, v50
    v_and_b32 v90, 0xffff0000, v52
    buffer_load_dwordx4 v202, s[32:35], s20 offen offset:2048  lds
    v_mul_f32 v104, v95, v80
    v_mul_f32 v105, v95, v81
    v_mul_f32 v106, v95, v82
    v_mul_f32 v107, v95, v83
    v_mul_f32 v108, v95, v84
    buffer_load_dwordx4 v203, s[32:35], s20 offen offset:3072  lds
    v_mul_f32 v109, v95, v85
    v_mul_f32 v110, v95, v86
    v_mul_f32 v111, v95, v87
    v_fmac_f32 v104, v94, v81
    v_fmac_f32 v105, v94, v82
    s_add_u32 m0, s51, 16384
    s_add_u32 s60, s49, 3670016
    buffer_load_dwordx4 v204, s[36:39], s60 offen offset:0  lds
    v_fmac_f32 v106, v94, v83
    v_fmac_f32 v107, v94, v84
    v_fmac_f32 v108, v94, v85
    v_fmac_f32 v109, v94, v86
    v_fmac_f32 v110, v94, v87
    buffer_load_dwordx4 v205, s[36:39], s60 offen offset:1024  lds
    v_fmac_f32 v111, v94, v88
    v_fmac_f32 v104, v93, v82
    v_fmac_f32 v105, v93, v83
    v_fmac_f32 v106, v93, v84
    v_fmac_f32 v107, v93, v85
    buffer_load_dwordx4 v206, s[36:39], s60 offen offset:2048  lds
    v_fmac_f32 v108, v93, v86
    v_fmac_f32 v109, v93, v87
    v_fmac_f32 v110, v93, v88
    v_fmac_f32 v111, v93, v89
    v_fmac_f32 v104, v92, v83
    buffer_load_dwordx4 v207, s[36:39], s60 offen offset:3072  lds
    v_fmac_f32 v105, v92, v84
    v_fmac_f32 v106, v92, v85
    v_fmac_f32 v107, v92, v86
    v_fmac_f32 v108, v92, v87
    v_fmac_f32 v109, v92, v88
    s_add_u32 m0, s51, 20480
    s_nop 0
    buffer_load_dwordx4 v208, s[36:39], s60 offen offset:0  lds
    v_fmac_f32 v110, v92, v89
    v_fmac_f32 v111, v92, v90
    v_lshlrev_b32 v92, 16, v76
    v_and_b32 v93, 0xffff0000, v76
    v_lshlrev_b32 v94, 16, v77
    buffer_load_dwordx4 v209, s[36:39], s60 offen offset:1024  lds
    v_and_b32 v95, 0xffff0000, v77
    v_lshlrev_b32 v80, 16, v33
    v_lshlrev_b32 v81, 16, v35
    v_lshlrev_b32 v82, 16, v37
    v_lshlrev_b32 v83, 16, v39
    buffer_load_dwordx4 v210, s[36:39], s60 offen offset:2048  lds
    v_lshlrev_b32 v84, 16, v41
    v_lshlrev_b32 v85, 16, v43
    v_lshlrev_b32 v86, 16, v45
    v_lshlrev_b32 v87, 16, v47
    v_lshlrev_b32 v88, 16, v49
    v_lshlrev_b32 v89, 16, v51
    s_waitcnt lgkmcnt(0)
    s_waitcnt vmcnt(11)
    s_barrier
    s_add_u32 m0, s50, 45056
    s_add_u32 s20, s1, 1152
    buffer_load_dwordx4 v200, s[32:35], s20 offen offset:0  lds
    s_waitcnt vmcnt(39)
    s_mov_b32 s44, s28
    s_and_b32 s45, s29, 0xffff
    s_mov_b32 s46, 256
    s_mov_b32 s47, 0x20000
    s_mov_b32 s63, 0
PL2p:
    v_cmp_ne_u32 vcc, 1, v29
    s_cbranch_vccz PL2d
    s_sleep 1
    buffer_load_dwordx2 v[28:29], v221, s[44:47], 0 offen sc1
    s_add_u32 s63, s63, 1
    s_cmp_lt_u32 s63, 262144
    s_waitcnt vmcnt(0)
    s_cbranch_scc1 PL2p
PL2d:
    v_readfirstlane_b32 s21, v28
    v_mov_b32 v220, v28
    v_lshlrev_b32 v90, 16, v53
    v_mul_f32 v144, v95, v80
    s_load_dword s2, s[18:19], 262144
    v_mul_f32 v145, v95, v81
    buffer_load_dwordx4 v201, s[32:35], s20 offen offset:1024  lds
    v_mul_f32 v146, v95, v82
    v_mul_f32 v147, v95, v83
    s_load_dword s2, s[18:19], 262208
    v_mul_f32 v148, v95, v84
    v_mul_f32 v149, v95, v85
    v_mul_f32 v150, v95, v86
    v_mul_f32 v151, v95, v87
    buffer_load_dwordx4 v202, s[32:35], s20 offen offset:2048  lds
    s_load_dword s2, s[18:19], 262272
    v_fmac_f32 v144, v94, v81
    v_fmac_f32 v145, v94, v82
    v_fmac_f32 v146, v94, v83
    s_load_dword s2, s[18:19], 262336
    v_fmac_f32 v147, v94, v84
    buffer_load_dwordx4 v203, s[32:35], s20 offen offset:3072  lds
    v_fmac_f32 v148, v94, v85
    v_fmac_f32 v149, v94, v86
    v_fmac_f32 v150, v94, v87
    s_load_dword s2, s[18:19], 262400
    v_fmac_f32 v151, v94, v88
    v_fmac_f32 v144, v93, v82
    v_fmac_f32 v145, v93, v83
    s_add_u32 m0, s51, 61440
    s_add_u32 s60, s49, 4128768
    buffer_load_dwordx4 v204, s[36:39], s60 offen offset:0  lds
    s_load_dword s2, s[18:19], 262464
    v_fmac_f32 v146, v93, v84
    v_fmac_f32 v147, v93, v85
    v_fmac_f32 v148, v93, v86
    v_fmac_f32 v149, v93, v87
    s_load_dword s2, s[18:19], 262528
    buffer_load_dwordx4 v205, s[36:39], s60 offen offset:1024  lds
    v_fmac_f32 v150, v93, v88
    v_fmac_f32 v151, v93, v89
    v_fmac_f32 v144, v92, v83
    s_load_dword s2, s[18:19], 262592
    v_fmac_f32 v145, v92, v84
    v_fmac_f32 v146, v92, v85
    v_fmac_f32 v147, v92, v86
    buffer_load_dwordx4 v206, s[36:39], s60 offen offset:2048  lds
    v_fmac_f32 v148, v92, v87
    s_load_dword s2, s[18:19], 262656
    v_fmac_f32 v149, v92, v88
    v_fmac_f32 v150, v92, v89
    v_fmac_f32 v151, v92, v90
    s_load_dword s2, s[18:19], 262720
    buffer_load_dwordx4 v207, s[36:39], s60 offen offset:3072  lds
    v_lshlrev_b32 v80, 16, v54
    v_lshlrev_b32 v81, 16, v56
    v_lshlrev_b32 v82, 16, v58
    v_lshlrev_b32 v83, 16, v60
    s_load_dword s2, s[18:19], 262784
    v_lshlrev_b32 v84, 16, v62
    v_lshlrev_b32 v85, 16, v64
    s_add_u32 m0, s51, 65536
    s_nop 0
    buffer_load_dwordx4 v208, s[36:39], s60 offen offset:0  lds
    v_lshlrev_b32 v86, 16, v66
    s_load_dword s2, s[18:19], 262848
    v_lshlrev_b32 v87, 16, v68
    v_mul_f32 v96, v96, v80
    v_mul_f32 v97, v97, v81
    v_mul_f32 v98, v98, v82
    buffer_load_dwordx4 v209, s[36:39], s60 offen offset:1024  lds
    s_load_dword s2, s[18:19], 262912
    v_mul_f32 v99, v99, v83
    v_mul_f32 v100, v100, v84
    v_mul_f32 v101, v101, v85
    s_load_dword s2, s[18:19], 262976
    v_mul_f32 v102, v102, v86
    v_mul_f32 v103, v103, v87
    buffer_load_dwordx4 v210, s[36:39], s60 offen offset:2048  lds
    v_cvt_pk_bf16_f32 v163, v97, v96
    v_cvt_pk_bf16_f32 v162, v99, v98
    s_load_dword s2, s[18:19], 263040
    v_cvt_pk_bf16_f32 v161, v101, v100
    v_cvt_pk_bf16_f32 v160, v103, v102
    v_and_b32 v80, 0xffff0000, v54
    s_load_dword s2, s[18:19], 263104
    s_lshl_b32 s52, s6, 7
    s_add_u32 s52, s52, 31522816
    s_cmp_eq_u32 s3, 0
    s_cselect_b32 s52, s52, 268435456
    s_mov_b32 exec_hi, 0
    buffer_store_dword v220, v234, s[40:43], s52 offen offset:0 sc1
    s_mov_b64 exec, -1
    buffer_store_dwordx4 v[160:163], v25, s[40:43], 0 offen sc1
    s_waitcnt vmcnt(13)
    s_barrier
    s_add_u32 m0, s50, 90112
    s_add_u32 s20, s1, 1280
    buffer_load_dwordx4 v200, s[32:35], s20 offen offset:0  lds
    v_and_b32 v81, 0xffff0000, v56
    v_and_b32 v82, 0xffff0000, v58
    v_and_b32 v83, 0xffff0000, v60
    v_and_b32 v84, 0xffff0000, v62
    s_load_dword s2, s[18:19], 65536
    v_and_b32 v85, 0xffff0000, v64
    buffer_load_dwordx4 v201, s[32:35], s20 offen offset:1024  lds
    v_and_b32 v86, 0xffff0000, v66
    v_and_b32 v87, 0xffff0000, v68
    s_load_dword s2, s[18:19], 65600
    v_mul_f32 v104, v104, v80
    v_mul_f32 v105, v105, v81
    v_mul_f32 v106, v106, v82
    buffer_load_dwordx4 v202, s[32:35], s20 offen offset:2048  lds
    s_load_dword s2, s[18:19], 65664
    v_mul_f32 v107, v107, v83
    v_mul_f32 v108, v108, v84
    v_mul_f32 v109, v109, v85
    v_mul_f32 v110, v110, v86
    s_load_dword s2, s[18:19], 65728
    buffer_load_dwordx4 v203, s[32:35], s20 offen offset:3072  lds
    v_mul_f32 v111, v111, v87
    v_cvt_pk_bf16_f32 v167, v105, v104
    v_cvt_pk_bf16_f32 v166, v107, v106
    s_load_dword s2, s[18:19], 65792
    v_cvt_pk_bf16_f32 v165, v109, v108
    v_cvt_pk_bf16_f32 v164, v111, v110
    v_lshlrev_b32 v92, 16, v78
    s_add_u32 m0, s51, 106496
    s_add_u32 s60, s49, 4587520
    buffer_load_dwordx4 v204, s[36:39], s60 offen offset:0  lds
    s_load_dword s2, s[18:19], 65856
    v_and_b32 v93, 0xffff0000, v78
    v_lshlrev_b32 v94, 16, v79
    v_and_b32 v95, 0xffff0000, v79
    v_and_b32 v80, 0xffff0000, v33
    s_load_dword s2, s[18:19], 65920
    buffer_load_dwordx4 v205, s[36:39], s60 offen offset:1024  lds
    v_and_b32 v81, 0xffff0000, v35
    v_and_b32 v82, 0xffff0000, v37
    v_and_b32 v83, 0xffff0000, v39
    s_load_dword s2, s[18:19], 65984
    v_and_b32 v84, 0xffff0000, v41
    v_and_b32 v85, 0xffff0000, v43
    buffer_load_dwordx4 v206, s[36:39], s60 offen offset:2048  lds
    v_and_b32 v86, 0xffff0000, v45
    s_load_dword s2, s[18:19], 66048
    v_and_b32 v87, 0xffff0000, v47
    v_and_b32 v88, 0xffff0000, v49
    v_and_b32 v89, 0xffff0000, v51
    v_and_b32 v90, 0xffff0000, v53
    buffer_load_dwordx4 v207, s[36:39], s60 offen offset:3072  lds
    s_load_dword s2, s[18:19], 66112
    v_mul_f32 v152, v95, v80
    v_mul_f32 v153, v95, v81
    v_mul_f32 v154, v95, v82
    s_load_dword s2, s[18:19], 66176
    v_mul_f32 v155, v95, v83
    v_mul_f32 v156, v95, v84
    s_add_u32 m0, s51, 110592
    s_nop 0
    buffer_load_dwordx4 v208, s[36:39], s60 offen offset:0  lds
    v_mul_f32 v157, v95, v85
    s_load_dword s2, s[18:19], 66240
    v_mul_f32 v158, v95, v86
    v_mul_f32 v159, v95, v87
    v_fmac_f32 v152, v94, v81
    v_fmac_f32 v153, v94, v82
    buffer_load_dwordx4 v209, s[36:39], s60 offen offset:1024  lds
    s_load_dword s2, s[18:19], 66304
    v_fmac_f32 v154, v94, v83
    v_fmac_f32 v155, v94, v84
    v_fmac_f32 v156, v94, v85
    s_load_dword s2, s[18:19], 66368
    v_fmac_f32 v157, v94, v86
    buffer_load_dwordx4 v210, s[36:39], s60 offen offset:2048  lds
    v_fmac_f32 v158, v94, v87
    v_fmac_f32 v159, v94, v88
    s_load_dword s2, s[18:19], 66432
    v_fmac_f32 v152, v93, v82
    v_fmac_f32 v153, v93, v83
    v_fmac_f32 v154, v93, v84
    s_load_dword s2, s[18:19], 66496
    buffer_store_dwordx4 v[164:167], v25, s[40:43], s56 offen sc1
    s_waitcnt vmcnt(14)
    s_barrier
    s_add_u32 m0, s50, 0
    s_add_u32 s20, s1, 1408
    buffer_load_dwordx4 v200, s[32:35], s20 offen offset:0  lds
    v_fmac_f32 v155, v93, v85
    v_fmac_f32 v156, v93, v86
    v_fmac_f32 v157, v93, v87
    v_fmac_f32 v158, v93, v88
    s_load_dword s2, s[18:19], 327680
    v_fmac_f32 v159, v93, v89
    buffer_load_dwordx4 v201, s[32:35], s20 offen offset:1024  lds
    v_fmac_f32 v152, v92, v83
    v_fmac_f32 v153, v92, v84
    s_load_dword s2, s[18:19], 327744
    v_fmac_f32 v154, v92, v85
    v_fmac_f32 v155, v92, v86
    v_fmac_f32 v156, v92, v87
    buffer_load_dwordx4 v202, s[32:35], s20 offen offset:2048  lds
    s_load_dword s2, s[18:19], 327808
    v_fmac_f32 v157, v92, v88
    v_fmac_f32 v158, v92, v89
    v_fmac_f32 v159, v92, v90
    v_lshlrev_b32 v80, 16, v55
    s_load_dword s2, s[18:19], 327872
    buffer_load_dwordx4 v203, s[32:35], s20 offen offset:3072  lds
    v_lshlrev_b32 v81, 16, v57
    v_lshlrev_b32 v82, 16, v59
    v_lshlrev_b32 v83, 16, v61
    s_load_dword s2, s[18:19], 327936
    v_lshlrev_b32 v84, 16, v63
    v_lshlrev_b32 v85, 16, v65
    v_lshlrev_b32 v86, 16, v67
    s_add_u32 m0, s51, 16384
    s_add_u32 s60, s49, 5046272
    buffer_load_dwordx4 v204, s[36:39], s60 offen offset:0  lds
    s_load_dword s2, s[18:19], 328000
    v_lshlrev_b32 v87, 16, v69
    v_mul_f32 v144, v144, v80
    v_mul_f32 v145, v145, v81
    v_mul_f32 v146, v146, v82
    s_load_dword s2, s[18:19], 328064
    buffer_load_dwordx4 v205, s[36:39], s60 offen offset:1024  lds
    v_mul_f32 v147, v147, v83
    v_mul_f32 v148, v148, v84
    v_mul_f32 v149, v149, v85
    s_load_dword s2, s[18:19], 328128
    v_mul_f32 v150, v150, v86
    v_mul_f32 v151, v151, v87
    buffer_load_dwordx4 v206, s[36:39], s60 offen offset:2048  lds
    v_cvt_pk_bf16_f32 v171, v145, v144
    s_load_dword s2, s[18:19], 328192
    v_cvt_pk_bf16_f32 v170, v147, v146
    v_cvt_pk_bf16_f32 v169, v149, v148
    v_cvt_pk_bf16_f32 v168, v151, v150
    v_and_b32 v80, 0xffff0000, v55
    buffer_load_dwordx4 v207, s[36:39], s60 offen offset:3072  lds
    s_load_dword s2, s[18:19], 328256
    v_and_b32 v81, 0xffff0000, v57
    v_and_b32 v82, 0xffff0000, v59
    v_and_b32 v83, 0xffff0000, v61
    s_load_dword s2, s[18:19], 328320
    v_and_b32 v84, 0xffff0000, v63
    v_and_b32 v85, 0xffff0000, v65
    s_add_u32 m0, s51, 20480
    s_nop 0
    buffer_load_dwordx4 v208, s[36:39], s60 offen offset:0  lds
    v_and_b32 v86, 0xffff0000, v67
    s_load_dword s2, s[18:19], 328384
    v_and_b32 v87, 0xffff0000, v69
    v_mul_f32 v152, v152, v80
    v_mul_f32 v153, v153, v81
    v_mul_f32 v154, v154, v82
    buffer_load_dwordx4 v209, s[36:39], s60 offen offset:1024  lds
    s_load_dword s2, s[18:19], 328448
    v_mul_f32 v155, v155, v83
    v_mul_f32 v156, v156, v84
    v_mul_f32 v157, v157, v85
    s_load_dword s2, s[18:19], 328512
    v_mul_f32 v158, v158, v86
    buffer_load_dwordx4 v210, s[36:39], s60 offen offset:2048  lds
    v_mul_f32 v159, v159, v87
    v_cvt_pk_bf16_f32 v175, v153, v152
    s_load_dword s2, s[18:19], 328576
    v_cvt_pk_bf16_f32 v174, v155, v154
    v_cvt_pk_bf16_f32 v173, v157, v156
    v_cvt_pk_bf16_f32 v172, v159, v158
    s_load_dword s2, s[18:19], 328640
    s_cmp_eq_u32 s3, 0
    s_cselect_b32 exec_lo, -1, 1
    s_mov_b32 exec_hi, 0
    s_mov_b32 s55, 31522816
    buffer_load_dword v28, v27, s[40:43], s55 offen sc1
    s_mov_b64 exec, -1
    buffer_store_dwordx4 v[168:171], v25, s[40:43], s57 offen sc1
    s_waitcnt vmcnt(14)
    s_barrier
    s_cmp_eq_u32 s7, 4
    s_cselect_b32 s20, 2048, 0
    s_cselect_b32 s60, 7340032, 0
    s_sub_u32 s1, s1, s20
    s_sub_u32 s49, s49, s60
    s_add_u32 m0, s50, 45056
    s_add_u32 s20, s1, 1536
    buffer_load_dwordx4 v200, s[32:35], s20 offen offset:0  lds
    v_lshrrev_b32 v3, 3, v2
    v_and_b32 v4, 2, v3
    s_load_dword s2, s[18:19], 131072
    v_and_b32 v5, 7, v2
    buffer_load_dwordx4 v201, s[32:35], s20 offen offset:1024  lds
    v_xor_b32 v4, v4, v5
    s_load_dword s2, s[18:19], 131136
    s_and_b32 s52, s3, 1
    s_lshl_b32 s53, s52, 2
    buffer_load_dwordx4 v202, s[32:35], s20 offen offset:2048  lds
    s_load_dword s2, s[18:19], 131200
    v_xor_b32 v4, s53, v4
    v_xor_b32 v5, v5, v3
    s_load_dword s2, s[18:19], 131264
    buffer_load_dwordx4 v203, s[32:35], s20 offen offset:3072  lds
    v_lshlrev_b32 v6, 11, v3
    v_lshl_add_u32 v216, v5, 4, v6
    s_load_dword s2, s[18:19], 131328
    s_lshl_b32 s52, s52, 4
    s_add_u32 m0, s51, 61440
    s_add_u32 s60, s49, 5505024
    buffer_load_dwordx4 v204, s[36:39], s60 offen offset:0  lds
    v_add_u32 v3, s52, v3
    s_load_dword s2, s[18:19], 131392
    v_lshlrev_b32 v3, 11, v3
    v_lshl_add_u32 v214, v4, 4, v3
    buffer_load_dwordx4 v205, s[36:39], s60 offen offset:1024  lds
    s_load_dword s2, s[18:19], 131456
    v_add_u32 v215, 15360, v214
    s_load_dword s2, s[18:19], 131520
    v_lshrrev_b32 v3, 1, v2
    v_and_b32 v4, 1, v2
    buffer_load_dwordx4 v206, s[36:39], s60 offen offset:2048  lds
    s_load_dword s2, s[18:19], 131584
    v_lshlrev_b32 v4, 7, v4
    v_lshl_add_u32 v223, v3, 9, v4
    s_load_dword s2, s[18:19], 131648
    buffer_load_dwordx4 v207, s[36:39], s60 offen offset:3072  lds
    v_lshl_add_u32 v225, v3, 11, v4
    s_mul_i32 s59, s3, 12928
    s_load_dword s2, s[18:19], 131712
    s_add_u32 s59, s59, 110080
    s_add_u32 m0, s51, 65536
    s_nop 0
    buffer_load_dwordx4 v208, s[36:39], s60 offen offset:0  lds
    v_add_u32 v9, 1, v7
    s_load_dword s2, s[18:19], 131776
    v_and_b32 v9, 1, v9
    v_mul_u32_u24 v11, 4158, v9
    buffer_load_dwordx4 v209, s[36:39], s60 offen offset:1024  lds
    s_load_dword s2, s[18:19], 131840
    v_lshl_add_u32 v11, v7, 1, v11
    v_lshl_add_u32 v11, v8, 4, v11
    s_load_dword s2, s[18:19], 131904
    buffer_load_dwordx4 v210, s[36:39], s60 offen offset:2048  lds
    v_add_u32 v11, 4610, v11
    v_add_u32 v11, s59, v11
    s_load_dword s2, s[18:19], 131968
    v_add_u32 v12, 1024, v11
    s_load_dword s2, s[18:19], 132032
    buffer_store_dwordx4 v[172:175], v25, s[40:43], s58 offen sc1
    s_waitcnt vmcnt(14)
    s_barrier
    s_add_u32 m0, s50, 90112
    s_add_u32 s20, s1, 1664
    buffer_load_dwordx4 v200, s[32:35], s20 offen offset:0  lds
    v_add_u32 v13, 2048, v11
    v_add_u32 v14, 3072, v11
    s_load_dword s2, s[18:19], 393216
    v_lshlrev_b32 v15, 5, v7
    buffer_load_dwordx4 v201, s[32:35], s20 offen offset:1024  lds
    v_sub_u32 v15, 480, v15
    s_load_dword s2, s[18:19], 393280
    v_lshl_add_u32 v15, v8, 4, v15
    v_add_u32 v15, s59, v15
    buffer_load_dwordx4 v202, s[32:35], s20 offen offset:2048  lds
    s_load_dword s2, s[18:19], 393344
    v_lshlrev_b32 v9, 5, v7
    v_lshl_add_u32 v9, v8, 3, v9
    s_load_dword s2, s[18:19], 393408
    buffer_load_dwordx4 v203, s[32:35], s20 offen offset:3072  lds
    v_sub_u32 v10, 504, v9
    v_add_u32 v10, s59, v10
    s_load_dword s2, s[18:19], 393472
    v_add_u32 v9, s59, v9
    v_add_u32 v217, s59, v212
    s_add_u32 m0, s51, 106496
    s_add_u32 s60, s49, 5963776
    buffer_load_dwordx4 v204, s[36:39], s60 offen offset:0  lds
    s_load_dword s2, s[18:19], 393536
    v_lshlrev_b32 v218, 3, v2
    v_add_u32 v218, s59, v218
    s_load_dword s2, s[18:19], 393600
    buffer_load_dwordx4 v205, s[36:39], s60 offen offset:1024  lds
    v_lshlrev_b32 v5, 1, v8
    v_xor_b32 v5, v5, v7
    s_load_dword s2, s[18:19], 393664
    v_lshlrev_b32 v3, 12, v8
    buffer_load_dwordx4 v206, s[36:39], s60 offen offset:2048  lds
    v_lshl_add_u32 v226, v5, 4, v3
    s_load_dword s2, s[18:19], 393728
    v_xor_b32 v5, 8, v5
    v_lshl_add_u32 v227, v5, 4, v3
    buffer_load_dwordx4 v207, s[36:39], s60 offen offset:3072  lds
    s_load_dword s2, s[18:19], 393792
    v_mov_b32 v140, 0
    v_mov_b32 v141, 0
    s_load_dword s2, s[18:19], 393856
    v_mov_b32 v142, 0
    s_add_u32 m0, s51, 110592
    s_nop 0
    buffer_load_dwordx4 v208, s[36:39], s60 offen offset:0  lds
    v_lshlrev_b32 v143, 16, v233
    s_load_dword s2, s[18:19], 393920
    v_cmp_eq_u32 vcc, 3, v2
    v_lshrrev_b32 v3, 1, v2
    buffer_load_dwordx4 v209, s[36:39], s60 offen offset:1024  lds
    s_load_dword s2, s[18:19], 393984
    v_mul_u32_u24 v3, 4128, v3
    v_cndmask_b32 v143, 0, v143, vcc
    s_load_dword s2, s[18:19], 394048
    buffer_load_dwordx4 v210, s[36:39], s60 offen offset:2048  lds
    v_add_u32 v192, v217, v3
    v_lshlrev_b32 v6, 16, v232
    s_load_dword s2, s[18:19], 394112
    v_mov_b32 v32, 0
    s_load_dword s2, s[18:19], 394176
    s_waitcnt vmcnt(24)
    s_cmp_eq_u32 s3, 0
    s_cselect_b32 exec_lo, -1, 1
    s_mov_b32 exec_hi, 0
    s_mov_b32 s63, 0
PL3p:
    v_cmp_ne_u32 vcc, s21, v28
    s_cbranch_vccz PL3d
    s_sleep 1
    buffer_load_dword v28, v27, s[40:43], s55 offen sc1
    s_add_u32 s63, s63, 1
    s_cmp_lt_u32 s63, 262144
    s_waitcnt vmcnt(0)
    s_cbranch_scc1 PL3p
PL3d:
    s_mov_b64 exec, -1
    s_waitcnt vmcnt(11)
    s_lshl_b32 s52, s62, 7
    s_add_u32 s52, s52, 31588352
    s_mov_b32 exec_hi, 0
    buffer_store_dword v220, v234, s[40:43], s52 offen offset:0 sc1
    s_mov_b64 exec, -1
    s_waitcnt vmcnt(13)
    s_barrier
    s_add_u32 m0, s50, 0
    s_add_u32 s20, s1, 1792
    buffer_load_dwordx4 v200, s[32:35], s20 offen offset:0  lds
    v_mov_b32 v33, 0
    v_mov_b32 v34, 0
    s_load_dword s2, s[18:19], 196608
    v_mov_b32 v35, 0
    buffer_load_dwordx4 v201, s[32:35], s20 offen offset:1024  lds
    v_mov_b32 v36, 0
    s_load_dword s2, s[18:19], 196672
    v_mov_b32 v37, 0
    v_mov_b32 v38, 0
    buffer_load_dwordx4 v202, s[32:35], s20 offen offset:2048  lds
    s_load_dword s2, s[18:19], 196736
    v_mov_b32 v39, 0
    v_mov_b32 v40, 0
    s_load_dword s2, s[18:19], 196800
    buffer_load_dwordx4 v203, s[32:35], s20 offen offset:3072  lds
    v_mov_b32 v41, 0
    v_mov_b32 v42, 0
    s_load_dword s2, s[18:19], 196864
    v_mov_b32 v43, 0
    v_mov_b32 v44, 0
    s_add_u32 m0, s51, 16384
    s_add_u32 s60, s49, 6422528
    buffer_load_dwordx4 v204, s[36:39], s60 offen offset:0  lds
    s_load_dword s2, s[18:19], 196928
    v_mov_b32 v45, 0
    v_mov_b32 v46, 0
    s_load_dword s2, s[18:19], 196992
    buffer_load_dwordx4 v205, s[36:39], s60 offen offset:1024  lds
    v_mov_b32 v47, 0
    v_mov_b32 v48, 0
    s_load_dword s2, s[18:19], 197056
    v_mov_b32 v49, 0
    buffer_load_dwordx4 v206, s[36:39], s60 offen offset:2048  lds
    v_mov_b32 v50, 0
    s_load_dword s2, s[18:19], 197120
    v_mov_b32 v51, 0
    v_mov_b32 v52, 0
    buffer_load_dwordx4 v207, s[36:39], s60 offen offset:3072  lds
    s_load_dword s2, s[18:19], 197184
    v_mov_b32 v53, 0
    v_mov_b32 v54, 0
    s_load_dword s2, s[18:19], 197248
    v_mov_b32 v55, 0
    s_add_u32 m0, s51, 20480
    s_nop 0
    buffer_load_dwordx4 v208, s[36:39], s60 offen offset:0  lds
    v_mov_b32 v56, 0
    s_load_dword s2, s[18:19], 197312
    v_mov_b32 v57, 0
    v_mov_b32 v58, 0
    buffer_load_dwordx4 v209, s[36:39], s60 offen offset:1024  lds
    s_load_dword s2, s[18:19], 197376
    v_mov_b32 v59, 0
    v_mov_b32 v60, 0
    s_load_dword s2, s[18:19], 197440
    buffer_load_dwordx4 v210, s[36:39], s60 offen offset:2048  lds
    v_mov_b32 v61, 0
    v_mov_b32 v62, 0
    s_load_dword s2, s[18:19], 197504
    v_mov_b32 v63, 0
    s_load_dword s2, s[18:19], 197568
    s_lshl_b32 s55, s5, 14
    s_lshl_b32 s52, s3, 12
    s_add_u32 s55, s55, s52
    s_add_u32 s55, s55, 29360128
    buffer_load_dwordx4 v[144:147], v212, s[40:43], s55 offen offset:0 sc1
    buffer_load_dwordx4 v[148:151], v212, s[40:43], s55 offen offset:1024 sc1
    buffer_load_dwordx4 v[152:155], v212, s[40:43], s55 offen offset:2048 sc1
    buffer_load_dwordx4 v[156:159], v212, s[40:43], s55 offen offset:3072 sc1
    s_lshl_b32 s52, s3, 8
    s_add_u32 m0, s52, 162816
    s_lshl_b32 s53, s4, 10
    s_add_u32 s52, s52, s53
    s_add_u32 s52, s52, 30408704
    buffer_load_dword v26, s[40:43], s52 offen sc1 lds
    s_waitcnt vmcnt(17)
    s_barrier
    s_add_u32 m0, s50, 45056
    s_add_u32 s20, s1, 1920
    buffer_load_dwordx4 v200, s[32:35], s20 offen offset:0  lds
    buffer_load_dwordx4 v201, s[32:35], s20 offen offset:1024  lds
    buffer_load_dwordx4 v202, s[32:35], s20 offen offset:2048  lds
    buffer_load_dwordx4 v203, s[32:35], s20 offen offset:3072  lds
    s_add_u32 m0, s51, 61440
    s_add_u32 s60, s49, 6881280
    buffer_load_dwordx4 v204, s[36:39], s60 offen offset:0  lds
    buffer_load_dwordx4 v205, s[36:39], s60 offen offset:1024  lds
    buffer_load_dwordx4 v206, s[36:39], s60 offen offset:2048  lds
    buffer_load_dwordx4 v207, s[36:39], s60 offen offset:3072  lds
    s_add_u32 m0, s51, 65536
    s_nop 0
    buffer_load_dwordx4 v208, s[36:39], s60 offen offset:0  lds
    buffer_load_dwordx4 v209, s[36:39], s60 offen offset:1024  lds
    buffer_load_dwordx4 v210, s[36:39], s60 offen offset:2048  lds
    s_lshr_b32 s54, s6, 5
    s_lshl_b32 s54, s54, 14
    s_and_b32 s52, s62, 96
    s_lshl_b32 s52, s52, 2
    s_add_u32 s54, s54, s52
    s_add_u32 s54, s54, 31588352
    s_cmp_eq_u32 s3, 0
    s_cselect_b32 exec_lo, -1, 1
    s_mov_b32 exec_hi, 0
    buffer_load_dword v28, v235, s[40:43], s54 offen sc1
    s_mov_b64 exec, -1
    s_waitcnt vmcnt(17)
    s_barrier
L_p2:
    s_mov_b32 s44, s16
    s_and_b32 s45, s17, 0xffff
    s_mov_b32 s46, 4194304
    s_mov_b32 s47, 0x20000
    s_lshl_b32 s53, s62, 12
    s_add_u32 m0, s59, 4640
    s_nop 0
    buffer_load_dwordx4 v212, s[44:47], s53 offen offset:0 lds
    buffer_load_dwordx4 v212, s[44:47], s53 offen offset:1024 lds
    buffer_load_dwordx4 v212, s[44:47], s53 offen offset:2048 lds
    buffer_load_dwordx4 v212, s[44:47], s53 offen offset:3072 lds
    s_add_u32 m0, s59, 8800
    s_add_u32 s53, s53, 2
    buffer_load_dwordx4 v212, s[44:47], s53 offen offset:0 lds
    buffer_load_dwordx4 v212, s[44:47], s53 offen offset:1024 lds
    buffer_load_dwordx4 v212, s[44:47], s53 offen offset:2048 lds
    buffer_load_dwordx4 v212, s[44:47], s53 offen offset:3072 lds
    s_mov_b32 s36, s24
    s_and_b32 s37, s25, 0xffff
    s_mov_b32 s38, 7340032
    s_mov_b32 s39, 0x20000
    s_waitcnt lgkmcnt(0)
    s_lshl_b32 s22, s3, 11
    s_add_u32 s22, s22, 16384
    s_and_b32 s51, s5, 3
    s_lshr_b32 s52, s3, 1
    s_lshl_b32 s53, s5, 7
    s_add_u32 s23, s48, s53
    s_mul_i32 s20, s52, 458752
    s_add_u32 s20, s20, s53
    s_mul_i32 s0, s51, 458752
    s_lshl_b32 s52, s52, 18
    s_add_u32 s0, s0, s52
    s_add_u32 s0, s0, s53
    s_lshl_b32 s60, s4, 3
    s_lshl_b32 s52, s3, 1
    s_add_u32 s60, s60, s52
    s_mul_i32 s60, s60, 114688
    s_add_u32 s60, s60, 8388608
    s_lshl_b32 s52, s51, 11
    s_add_u32 s7, s60, s52
    s_lshr_b32 s18, s5, 2
    s_mul_i32 s19, s18, 1835008
    s_lshl_b32 s1, s4, 13
    s_add_u32 s1, s1, 32112640
    s_lshr_b32 s52, s3, 1
    s_lshl_b32 s52, s52, 8
    s_add_u32 s1, s1, s52
    s_lshl_b32 s52, s51, 9
    s_add_u32 s55, s1, s52
    s_waitcnt vmcnt(20)
    v_add_f32 v144, v144, v152
    v_add_f32 v145, v145, v153
    v_add_f32 v146, v146, v154
    v_add_f32 v147, v147, v155
    v_add_f32 v148, v148, v156
    v_add_f32 v149, v149, v157
    v_add_f32 v150, v150, v158
    v_add_f32 v151, v151, v159
    v_add_f32 v144, v144, v148
    v_add_f32 v145, v145, v149
    v_add_f32 v146, v146, v150
    v_add_f32 v147, v147, v151
    s_mul_i32 s52, s3, 896
    s_add_u32 s52, s52, 90112
    v_add_u32 v3, s52, v212
    s_mov_b32 exec_hi, 0xffffff
    ds_write_b128 v3, v[144:147]
    s_mov_b32 exec_hi, -1
    v_mov_b32 v4, 162812
    ds_write_b32 v4, v220
    v_mov_b32 v4, 162808
    ds_write_b32 v4, v221
    s_waitcnt vmcnt(8)
    s_cmp_eq_u32 s3, 0
    s_cselect_b32 exec_lo, -1, 1
    s_mov_b32 exec_hi, 0
    s_mov_b32 s63, 0
PL1p:
    v_cmp_ne_u32 vcc, s21, v28
    s_cbranch_vccz PL1d
    s_sleep 1
    buffer_load_dword v28, v235, s[40:43], s54 offen sc1
    s_add_u32 s63, s63, 1
    s_cmp_lt_u32 s63, 262144
    s_waitcnt vmcnt(0)
    s_cbranch_scc1 PL1p
PL1d:
    s_mov_b64 exec, -1
    s_waitcnt vmcnt(9)
    s_waitcnt lgkmcnt(0)
    s_barrier
    s_lshl_b32 s52, s62, 12
    s_add_u32 s52, s52, 4194304
    s_mov_b32 m0, s59
    s_nop 0
    buffer_load_dwordx4 v212, s[40:43], s52 offen offset:0 sc1 lds
    buffer_load_dwordx4 v212, s[40:43], s52 offen offset:1024 sc1 lds
    buffer_load_dwordx4 v212, s[40:43], s52 offen offset:2048 sc1 lds
    buffer_load_dwordx4 v212, s[40:43], s52 offen offset:3072 sc1 lds
    s_getpc_b64 s[52:53]
PC8:
    s_add_u32 s52, s52, L_p2-PC8
    s_addc_u32 s53, s53, (L_p2-PC8)>>32
    v_lshlrev_b32 v250, 7, v2
    s_lshl_b32 s63, s3, 13
    v_add_u32 v250, s63, v250
    v_min_u32 v250, K_end-L_p2-68, v250
    global_load_dword v250, v250, s[52:53]
    v_add_u32 v3, 90112, v18
    ds_read_b32 v196, v3 offset:0
    ds_read_b32 v197, v3 offset:896
    ds_read_b32 v198, v3 offset:1792
    ds_read_b32 v199, v3 offset:2688
    v_add_u32 v18, 161792, v18
    ds_write_b64 v218, v[140:141] offset:4096
    s_mov_b64 exec, 15
    ds_write_b128 v192, v[140:143] offset:4608
    s_mov_b64 exec, -1
    s_waitcnt lgkmcnt(2)
    v_add_f32 v196, v196, v197
    v_add_f32 v198, v198, v199
    v_add_f32 v196, v196, v198
    ds_write_b32 v18, v196
    s_waitcnt lgkmcnt(0)
    s_barrier
    s_waitcnt vmcnt(1)
    s_waitcnt lgkmcnt(0)
    ds_read2_b32 v[64:65], v11 offset0:0 offset1:1
    ds_read2_b32 v[66:67], v11 offset0:2 offset1:3
    ds_read_b128 v[96:99], v15 offset:3584
    ds_read2_b32 v[68:69], v11 offset0:128 offset1:129
    ds_read2_b32 v[70:71], v11 offset0:130 offset1:131
    ds_read_b128 v[100:103], v15 offset:3072
    ds_read2_b32 v[72:73], v12 offset0:0 offset1:1
    ds_read2_b32 v[74:75], v12 offset0:2 offset1:3
    ds_read_b128 v[104:107], v15 offset:2560
    ds_read2_b32 v[76:77], v12 offset0:128 offset1:129
    ds_read2_b32 v[78:79], v12 offset0:130 offset1:131
    ds_read_b128 v[108:111], v15 offset:2048
    ds_read2_b32 v[80:81], v13 offset0:0 offset1:1
    ds_read2_b32 v[82:83], v13 offset0:2 offset1:3
    ds_read_b128 v[112:115], v15 offset:1536
    ds_read2_b32 v[84:85], v13 offset0:128 offset1:129
    ds_read2_b32 v[86:87], v13 offset0:130 offset1:131
    ds_read_b128 v[116:119], v15 offset:1024
    ds_read2_b32 v[88:89], v14 offset0:0 offset1:1
    ds_read2_b32 v[90:91], v14 offset0:2 offset1:3
    ds_read_b128 v[120:123], v15 offset:512
    ds_read2_b32 v[92:93], v14 offset0:128 offset1:129
    ds_read2_b32 v[94:95], v14 offset0:130 offset1:131
    ds_read_b128 v[124:127], v15 offset:0
    ds_read_b64 v[16:17], v10 offset:3584
    ds_read_b64 v[18:19], v10 offset:3072
    ds_read_b64 v[20:21], v10 offset:2560
    ds_read_b64 v[22:23], v10 offset:2048
    ds_read_b64 v[24:25], v10 offset:1536
    ds_read_b64 v[26:27], v10 offset:1024
    ds_read_b64 v[28:29], v10 offset:512
    ds_read_b64 v[30:31], v10 offset:0
    s_mov_b32 s58, 0
L_conv:
    s_waitcnt lgkmcnt(0)
    v_mfma_f32_16x16x32_bf16 v[32:35], v[64:67], v[96:99], v[32:35]
    ds_read2_b32 v[128:129], v11 offset0:16 offset1:17
    v_mfma_f32_16x16x32_bf16 v[36:39], v[64:67], v[100:103], v[36:39]
    ds_read2_b32 v[130:131], v11 offset0:18 offset1:19
    v_mfma_f32_16x16x32_bf16 v[36:39], v[68:71], v[96:99], v[36:39]
    ds_read_b128 v[160:163], v15 offset:3648
    v_mfma_f32_16x16x32_bf16 v[40:43], v[64:67], v[104:107], v[40:43]
    ds_read2_b32 v[132:133], v11 offset0:144 offset1:145
    v_mfma_f32_16x16x32_bf16 v[40:43], v[68:71], v[100:103], v[40:43]
    ds_read2_b32 v[134:135], v11 offset0:146 offset1:147
    v_mfma_f32_16x16x32_bf16 v[40:43], v[72:75], v[96:99], v[40:43]
    ds_read_b128 v[164:167], v15 offset:3136
    v_mfma_f32_16x16x32_bf16 v[44:47], v[64:67], v[108:111], v[44:47]
    ds_read2_b32 v[136:137], v12 offset0:16 offset1:17
    v_mfma_f32_16x16x32_bf16 v[44:47], v[68:71], v[104:107], v[44:47]
    ds_read2_b32 v[138:139], v12 offset0:18 offset1:19
    v_mfma_f32_16x16x32_bf16 v[44:47], v[72:75], v[100:103], v[44:47]
    ds_read_b128 v[168:171], v15 offset:2624
    v_mfma_f32_16x16x32_bf16 v[44:47], v[76:79], v[96:99], v[44:47]
    ds_read2_b32 v[140:141], v12 offset0:144 offset1:145
    v_mfma_f32_16x16x32_bf16 v[48:51], v[64:67], v[112:115], v[48:51]
    ds_read2_b32 v[142:143], v12 offset0:146 offset1:147
    v_mfma_f32_16x16x32_bf16 v[48:51], v[68:71], v[108:111], v[48:51]
    ds_read_b128 v[172:175], v15 offset:2112
    v_mfma_f32_16x16x32_bf16 v[48:51], v[72:75], v[104:107], v[48:51]
    ds_read2_b32 v[144:145], v13 offset0:16 offset1:17
    v_mfma_f32_16x16x32_bf16 v[48:51], v[76:79], v[100:103], v[48:51]
    ds_read2_b32 v[146:147], v13 offset0:18 offset1:19
    v_mfma_f32_16x16x32_bf16 v[48:51], v[80:83], v[96:99], v[48:51]
    ds_read_b128 v[176:179], v15 offset:1600
    v_mfma_f32_16x16x32_bf16 v[52:55], v[64:67], v[116:119], v[52:55]
    ds_read2_b32 v[148:149], v13 offset0:144 offset1:145
    v_mfma_f32_16x16x32_bf16 v[52:55], v[68:71], v[112:115], v[52:55]
    ds_read2_b32 v[150:151], v13 offset0:146 offset1:147
    v_mfma_f32_16x16x32_bf16 v[52:55], v[72:75], v[108:111], v[52:55]
    ds_read_b128 v[180:183], v15 offset:1088
    v_mfma_f32_16x16x32_bf16 v[52:55], v[76:79], v[104:107], v[52:55]
    ds_read2_b32 v[152:153], v14 offset0:16 offset1:17
    v_mfma_f32_16x16x32_bf16 v[52:55], v[80:83], v[100:103], v[52:55]
    ds_read2_b32 v[154:155], v14 offset0:18 offset1:19
    v_mfma_f32_16x16x32_bf16 v[52:55], v[84:87], v[96:99], v[52:55]
    ds_read_b128 v[184:187], v15 offset:576
    v_mfma_f32_16x16x32_bf16 v[56:59], v[64:67], v[120:123], v[56:59]
    ds_read2_b32 v[156:157], v14 offset0:144 offset1:145
    v_mfma_f32_16x16x32_bf16 v[56:59], v[68:71], v[116:119], v[56:59]
    ds_read2_b32 v[158:159], v14 offset0:146 offset1:147
    v_mfma_f32_16x16x32_bf16 v[56:59], v[72:75], v[112:115], v[56:59]
    ds_read_b128 v[188:191], v15 offset:64
    v_mfma_f32_16x16x32_bf16 v[56:59], v[76:79], v[108:111], v[56:59]
    v_mfma_f32_16x16x32_bf16 v[56:59], v[80:83], v[104:107], v[56:59]
    v_mfma_f32_16x16x32_bf16 v[56:59], v[84:87], v[100:103], v[56:59]
    s_branch L_hk
L_hr:
    v_mfma_f32_16x16x32_bf16 v[56:59], v[88:91], v[96:99], v[56:59]
    v_mfma_f32_16x16x32_bf16 v[60:63], v[64:67], v[124:127], v[60:63]
    v_mfma_f32_16x16x32_bf16 v[60:63], v[68:71], v[120:123], v[60:63]
    v_mfma_f32_16x16x32_bf16 v[60:63], v[72:75], v[116:119], v[60:63]
    v_mfma_f32_16x16x32_bf16 v[60:63], v[76:79], v[112:115], v[60:63]
    v_mfma_f32_16x16x32_bf16 v[60:63], v[80:83], v[108:111], v[60:63]
    v_mfma_f32_16x16x32_bf16 v[60:63], v[84:87], v[104:107], v[60:63]
    v_mfma_f32_16x16x32_bf16 v[60:63], v[88:91], v[100:103], v[60:63]
    v_mfma_f32_16x16x32_bf16 v[60:63], v[92:95], v[96:99], v[60:63]
    s_waitcnt lgkmcnt(0)
    v_mfma_f32_16x16x32_bf16 v[32:35], v[128:131], v[160:163], v[32:35]
    ds_read2_b32 v[64:65], v11 offset0:32 offset1:33
    v_mfma_f32_16x16x32_bf16 v[36:39], v[128:131], v[164:167], v[36:39]
    ds_read2_b32 v[66:67], v11 offset0:34 offset1:35
    v_mfma_f32_16x16x32_bf16 v[36:39], v[132:135], v[160:163], v[36:39]
    ds_read_b128 v[96:99], v15 offset:3712
    v_mfma_f32_16x16x32_bf16 v[40:43], v[128:131], v[168:171], v[40:43]
    ds_read2_b32 v[68:69], v11 offset0:160 offset1:161
    v_mfma_f32_16x16x32_bf16 v[40:43], v[132:135], v[164:167], v[40:43]
    ds_read2_b32 v[70:71], v11 offset0:162 offset1:163
    v_mfma_f32_16x16x32_bf16 v[40:43], v[136:139], v[160:163], v[40:43]
    ds_read_b128 v[100:103], v15 offset:3200
    v_mfma_f32_16x16x32_bf16 v[44:47], v[128:131], v[172:175], v[44:47]
    ds_read2_b32 v[72:73], v12 offset0:32 offset1:33
    v_mfma_f32_16x16x32_bf16 v[44:47], v[132:135], v[168:171], v[44:47]
    ds_read2_b32 v[74:75], v12 offset0:34 offset1:35
    v_mfma_f32_16x16x32_bf16 v[44:47], v[136:139], v[164:167], v[44:47]
    ds_read_b128 v[104:107], v15 offset:2688
    v_mfma_f32_16x16x32_bf16 v[44:47], v[140:143], v[160:163], v[44:47]
    ds_read2_b32 v[76:77], v12 offset0:160 offset1:161
    v_mfma_f32_16x16x32_bf16 v[48:51], v[128:131], v[176:179], v[48:51]
    ds_read2_b32 v[78:79], v12 offset0:162 offset1:163
    v_mfma_f32_16x16x32_bf16 v[48:51], v[132:135], v[172:175], v[48:51]
    ds_read_b128 v[108:111], v15 offset:2176
    v_mfma_f32_16x16x32_bf16 v[48:51], v[136:139], v[168:171], v[48:51]
    ds_read2_b32 v[80:81], v13 offset0:32 offset1:33
    v_mfma_f32_16x16x32_bf16 v[48:51], v[140:143], v[164:167], v[48:51]
    ds_read2_b32 v[82:83], v13 offset0:34 offset1:35
    v_mfma_f32_16x16x32_bf16 v[48:51], v[144:147], v[160:163], v[48:51]
    ds_read_b128 v[112:115], v15 offset:1664
    v_mfma_f32_16x16x32_bf16 v[52:55], v[128:131], v[180:183], v[52:55]
    ds_read2_b32 v[84:85], v13 offset0:160 offset1:161
    v_mfma_f32_16x16x32_bf16 v[52:55], v[132:135], v[176:179], v[52:55]
    ds_read2_b32 v[86:87], v13 offset0:162 offset1:163
    v_mfma_f32_16x16x32_bf16 v[52:55], v[136:139], v[172:175], v[52:55]
    ds_read_b128 v[116:119], v15 offset:1152
    v_mfma_f32_16x16x32_bf16 v[52:55], v[140:143], v[168:171], v[52:55]
    ds_read2_b32 v[88:89], v14 offset0:32 offset1:33
    v_mfma_f32_16x16x32_bf16 v[52:55], v[144:147], v[164:167], v[52:55]
    ds_read2_b32 v[90:91], v14 offset0:34 offset1:35
    v_mfma_f32_16x16x32_bf16 v[52:55], v[148:151], v[160:163], v[52:55]
    ds_read_b128 v[120:123], v15 offset:640
    v_mfma_f32_16x16x32_bf16 v[56:59], v[128:131], v[184:187], v[56:59]
    ds_read2_b32 v[92:93], v14 offset0:160 offset1:161
    v_mfma_f32_16x16x32_bf16 v[56:59], v[132:135], v[180:183], v[56:59]
    ds_read2_b32 v[94:95], v14 offset0:162 offset1:163
    v_mfma_f32_16x16x32_bf16 v[56:59], v[136:139], v[176:179], v[56:59]
    ds_read_b128 v[124:127], v15 offset:128
    v_mfma_f32_16x16x32_bf16 v[56:59], v[140:143], v[172:175], v[56:59]
    v_mfma_f32_16x16x32_bf16 v[56:59], v[144:147], v[168:171], v[56:59]
    v_mfma_f32_16x16x32_bf16 v[56:59], v[148:151], v[164:167], v[56:59]
    v_mfma_f32_16x16x32_bf16 v[56:59], v[152:155], v[160:163], v[56:59]
    v_mfma_f32_16x16x32_bf16 v[60:63], v[128:131], v[188:191], v[60:63]
    v_add_u32 v11, 128, v11
    v_mfma_f32_16x16x32_bf16 v[60:63], v[132:135], v[184:187], v[60:63]
    v_add_u32 v12, 128, v12
    v_mfma_f32_16x16x32_bf16 v[60:63], v[136:139], v[180:183], v[60:63]
    v_add_u32 v13, 128, v13
    v_mfma_f32_16x16x32_bf16 v[60:63], v[140:143], v[176:179], v[60:63]
    v_add_u32 v14, 128, v14
    v_mfma_f32_16x16x32_bf16 v[60:63], v[144:147], v[172:175], v[60:63]
    v_add_u32 v15, 128, v15
    v_mfma_f32_16x16x32_bf16 v[60:63], v[148:151], v[168:171], v[60:63]
    v_mfma_f32_16x16x32_bf16 v[60:63], v[152:155], v[164:167], v[60:63]
    s_add_u32 s58, s58, 1
    s_cmp_lt_u32 s58, 4
    v_mfma_f32_16x16x32_bf16 v[60:63], v[156:159], v[160:163], v[60:63]
    s_cbranch_scc1 L_conv
    s_branch L_cend
L_hk:
    s_setprio 1
    s_cmp_lg_u32 s58, 0
    s_cbranch_scc1 HK9
    s_add_u32 m0, s22, 0
    s_add_u32 s61, s0, 0
    s_add_u32 s61, s61, s19
    s_mov_b32 s49, s61
    buffer_load_dwordx4 v214, s[36:39], s49 offen  lds
    buffer_load_dwordx4 v215, s[36:39], s49 offen offset:1024  lds
    s_add_u32 m0, s22, 8192
    s_xor_b32 s49, s61, 128
    buffer_load_dwordx4 v214, s[36:39], s49 offen  lds
    buffer_load_dwordx4 v215, s[36:39], s49 offen offset:1024  lds
    s_branch L_hr
HK9:
    s_cmp_lg_u32 s58, 1
    s_cbranch_scc1 HK10
    s_add_u32 m0, s22, 16384
    s_xor_b32 s49, s61, 256
    buffer_load_dwordx4 v214, s[36:39], s49 offen  lds
    buffer_load_dwordx4 v215, s[36:39], s49 offen offset:1024  lds
    s_add_u32 m0, s22, 24576
    s_xor_b32 s49, s61, 384
    buffer_load_dwordx4 v214, s[36:39], s49 offen  lds
    buffer_load_dwordx4 v215, s[36:39], s49 offen offset:1024  lds
    s_branch L_hr
HK10:
    s_cmp_lg_u32 s58, 2
    s_cbranch_scc1 HK11
    s_add_u32 m0, s22, 49152
    s_add_u32 s61, s0, 65536
    s_add_u32 s61, s61, s19
    s_mov_b32 s49, s61
    buffer_load_dwordx4 v214, s[36:39], s49 offen  lds
    buffer_load_dwordx4 v215, s[36:39], s49 offen offset:1024  lds
    s_add_u32 m0, s22, 57344
    s_xor_b32 s49, s61, 128
    buffer_load_dwordx4 v214, s[36:39], s49 offen  lds
    buffer_load_dwordx4 v215, s[36:39], s49 offen offset:1024  lds
    s_branch L_hr
HK11:
    s_cmp_lg_u32 s58, 3
    s_cbranch_scc1 HK12
    s_add_u32 m0, s22, 65536
    s_xor_b32 s49, s61, 256
    buffer_load_dwordx4 v214, s[36:39], s49 offen  lds
    buffer_load_dwordx4 v215, s[36:39], s49 offen offset:1024  lds
    s_add_u32 m0, s22, 73728
    s_xor_b32 s49, s61, 384
    buffer_load_dwordx4 v214, s[36:39], s49 offen  lds
    buffer_load_dwordx4 v215, s[36:39], s49 offen offset:1024  lds
    s_branch L_hr
HK12:
    s_branch L_hr
L_cend:
    s_waitcnt lgkmcnt(0)
    v_and_b32 v64, 0xffff0000, v17
    v_lshlrev_b32 v65, 16, v17
    v_and_b32 v66, 0xffff0000, v16
    v_lshlrev_b32 v67, 16, v16
    v_fmac_f32 v32, v6, v64
    v_fmac_f32 v33, v6, v65
    v_fmac_f32 v34, v6, v66
    v_fmac_f32 v35, v6, v67
    v_cvt_pk_bf16_f32 v16, v32, v33
    v_cvt_pk_bf16_f32 v17, v34, v35
    ds_write_b64 v9, v[16:17] offset:4608
    v_and_b32 v64, 0xffff0000, v19
    v_lshlrev_b32 v65, 16, v19
    v_and_b32 v66, 0xffff0000, v18
    v_lshlrev_b32 v67, 16, v18
    v_fmac_f32 v36, v6, v64
    v_fmac_f32 v37, v6, v65
    v_fmac_f32 v38, v6, v66
    v_fmac_f32 v39, v6, v67
    v_cvt_pk_bf16_f32 v18, v36, v37
    v_cvt_pk_bf16_f32 v19, v38, v39
    ds_write_b64 v9, v[18:19] offset:5120
    v_and_b32 v64, 0xffff0000, v21
    v_lshlrev_b32 v65, 16, v21
    v_and_b32 v66, 0xffff0000, v20
    v_lshlrev_b32 v67, 16, v20
    v_fmac_f32 v40, v6, v64
    v_fmac_f32 v41, v6, v65
    v_fmac_f32 v42, v6, v66
    v_fmac_f32 v43, v6, v67
    v_cvt_pk_bf16_f32 v20, v40, v41
    v_cvt_pk_bf16_f32 v21, v42, v43
    ds_write_b64 v9, v[20:21] offset:5632
    v_and_b32 v64, 0xffff0000, v23
    v_lshlrev_b32 v65, 16, v23
    v_and_b32 v66, 0xffff0000, v22
    v_lshlrev_b32 v67, 16, v22
    v_fmac_f32 v44, v6, v64
    v_fmac_f32 v45, v6, v65
    v_fmac_f32 v46, v6, v66
    v_fmac_f32 v47, v6, v67
    v_cvt_pk_bf16_f32 v22, v44, v45
    v_cvt_pk_bf16_f32 v23, v46, v47
    ds_write_b64 v9, v[22:23] offset:6144
    v_and_b32 v64, 0xffff0000, v25
    v_lshlrev_b32 v65, 16, v25
    v_and_b32 v66, 0xffff0000, v24
    v_lshlrev_b32 v67, 16, v24
    v_fmac_f32 v48, v6, v64
    v_fmac_f32 v49, v6, v65
    v_fmac_f32 v50, v6, v66
    v_fmac_f32 v51, v6, v67
    v_cvt_pk_bf16_f32 v24, v48, v49
    v_cvt_pk_bf16_f32 v25, v50, v51
    ds_write_b64 v9, v[24:25] offset:6656
    v_and_b32 v64, 0xffff0000, v27
    v_lshlrev_b32 v65, 16, v27
    v_and_b32 v66, 0xffff0000, v26
    v_lshlrev_b32 v67, 16, v26
    v_fmac_f32 v52, v6, v64
    v_fmac_f32 v53, v6, v65
    v_fmac_f32 v54, v6, v66
    v_fmac_f32 v55, v6, v67
    v_cvt_pk_bf16_f32 v26, v52, v53
    v_cvt_pk_bf16_f32 v27, v54, v55
    ds_write_b64 v9, v[26:27] offset:7168
    v_and_b32 v64, 0xffff0000, v29
    v_lshlrev_b32 v65, 16, v29
    v_and_b32 v66, 0xffff0000, v28
    v_lshlrev_b32 v67, 16, v28
    v_fmac_f32 v56, v6, v64
    v_fmac_f32 v57, v6, v65
    v_fmac_f32 v58, v6, v66
    v_fmac_f32 v59, v6, v67
    v_cvt_pk_bf16_f32 v28, v56, v57
    v_cvt_pk_bf16_f32 v29, v58, v59
    ds_write_b64 v9, v[28:29] offset:7680
    v_and_b32 v64, 0xffff0000, v31
    v_lshlrev_b32 v65, 16, v31
    v_and_b32 v66, 0xffff0000, v30
    v_lshlrev_b32 v67, 16, v30
    v_fmac_f32 v60, v6, v64
    v_fmac_f32 v61, v6, v65
    v_fmac_f32 v62, v6, v66
    v_fmac_f32 v63, v6, v67
    v_cvt_pk_bf16_f32 v30, v60, v61
    v_cvt_pk_bf16_f32 v31, v62, v63
    ds_write_b64 v9, v[30:31] offset:8192
    ds_read_b128 v[80:83], v217 offset:4608
    ds_read_b128 v[84:87], v217 offset:5632
    ds_read_b128 v[88:91], v217 offset:6656
    ds_read_b128 v[92:95], v217 offset:7680
    s_waitcnt lgkmcnt(0)
    s_lshl_b32 s53, s62, 12
    s_add_u32 s53, s53, 25165824
    buffer_store_dwordx4 v[80:83], v212, s[40:43], s53 offen offset:0 sc1
    buffer_store_dwordx4 v[84:87], v212, s[40:43], s53 offen offset:1024 sc1
    buffer_store_dwordx4 v[88:91], v212, s[40:43], s53 offen offset:2048 sc1
    buffer_store_dwordx4 v[92:95], v212, s[40:43], s53 offen offset:3072 sc1
    s_waitcnt vmcnt(12)
    s_setprio 0
    s_barrier
    s_mov_b32 exec_lo, 0xff
    s_mov_b32 exec_hi, 0
    buffer_load_dword v222, v225, s[40:43], s55 offen offset:0 sc1
    s_mov_b64 exec, -1
    s_add_u32 m0, s22, 98304
    s_add_u32 s61, s0, 131072
    s_add_u32 s61, s61, s19
    s_mov_b32 s49, s61
    buffer_load_dwordx4 v214, s[36:39], s49 offen  lds
    buffer_load_dwordx4 v215, s[36:39], s49 offen offset:1024  lds
    s_add_u32 m0, s22, 106496
    s_xor_b32 s49, s61, 128
    buffer_load_dwordx4 v214, s[36:39], s49 offen  lds
    buffer_load_dwordx4 v215, s[36:39], s49 offen offset:1024  lds
    s_add_u32 m0, s22, 114688
    s_xor_b32 s49, s61, 256
    buffer_load_dwordx4 v214, s[36:39], s49 offen  lds
    buffer_load_dwordx4 v215, s[36:39], s49 offen offset:1024  lds
    s_add_u32 m0, s22, 122880
    s_xor_b32 s49, s61, 384
    buffer_load_dwordx4 v214, s[36:39], s49 offen  lds
    buffer_load_dwordx4 v215, s[36:39], s49 offen offset:1024  lds
    s_waitcnt vmcnt(13)
    s_barrier
    s_add_u32 m0, s22, 0
    s_cmp_le_u32 s18, 0
    s_cselect_b32 s19, 1835008, 0
    s_cselect_b32 s51, 8192, 0
    s_add_u32 s61, s0, 0
    s_add_u32 s61, s61, s19
    s_mov_b32 s49, s61
    buffer_load_dwordx4 v214, s[36:39], s49 offen  lds
    buffer_load_dwordx4 v215, s[36:39], s49 offen offset:1024  lds
    s_add_u32 m0, s22, 8192
    s_xor_b32 s49, s61, 128
    buffer_load_dwordx4 v214, s[36:39], s49 offen  lds
    buffer_load_dwordx4 v215, s[36:39], s49 offen offset:1024  lds
    s_add_u32 m0, s22, 16384
    s_xor_b32 s49, s61, 256
    buffer_load_dwordx4 v214, s[36:39], s49 offen  lds
    buffer_load_dwordx4 v215, s[36:39], s49 offen offset:1024  lds
    s_add_u32 m0, s22, 24576
    s_xor_b32 s49, s61, 384
    buffer_load_dwordx4 v214, s[36:39], s49 offen  lds
    buffer_load_dwordx4 v215, s[36:39], s49 offen offset:1024  lds
    s_waitcnt vmcnt(16)
    s_mov_b32 exec_lo, 0xff
    s_mov_b32 exec_hi, 0
    s_mov_b32 s63, 0
PL13p:
    v_cmp_ne_u32 vcc, s21, v222
    s_cbranch_vccz PL13d
    s_sleep 1
    buffer_load_dword v222, v225, s[40:43], s55 offen offset:0 sc1
    s_add_u32 s63, s63, 1
    s_cmp_lt_u32 s63, 262144
    s_waitcnt vmcnt(0)
    s_cbranch_scc1 PL13p
PL13d:
    s_mov_b64 exec, -1
    s_add_u32 m0, s50, 0
    s_add_u32 s48, s7, 0
    s_add_u32 s48, s48, s51
    buffer_load_dwordx4 v212, s[40:43], s48 offen sc1 lds
    buffer_load_dwordx4 v212, s[40:43], s48 offen offset:1024 sc1 lds
    buffer_load_dwordx4 v213, s[40:43], s48 offen offset:2048 sc1 lds
    buffer_load_dwordx4 v213, s[40:43], s48 offen offset:3072 sc1 lds
    s_waitcnt vmcnt(12)
    s_barrier
    s_add_u32 m0, s22, 49152
    s_cmp_le_u32 s18, 1
    s_cselect_b32 s19, 1835008, 0
    s_cselect_b32 s51, 8192, 0
    s_add_u32 s61, s0, 1835008
    s_add_u32 s61, s61, s19
    s_mov_b32 s49, s61
    buffer_load_dwordx4 v214, s[36:39], s49 offen  lds
    buffer_load_dwordx4 v215, s[36:39], s49 offen offset:1024  lds
    s_add_u32 m0, s22, 57344
    s_xor_b32 s49, s61, 128
    buffer_load_dwordx4 v214, s[36:39], s49 offen  lds
    buffer_load_dwordx4 v215, s[36:39], s49 offen offset:1024  lds
    s_add_u32 m0, s22, 65536
    s_xor_b32 s49, s61, 256
    buffer_load_dwordx4 v214, s[36:39], s49 offen  lds
    buffer_load_dwordx4 v215, s[36:39], s49 offen offset:1024  lds
    s_add_u32 m0, s22, 73728
    s_xor_b32 s49, s61, 384
    buffer_load_dwordx4 v214, s[36:39], s49 offen  lds
    buffer_load_dwordx4 v215, s[36:39], s49 offen offset:1024  lds
    s_add_u32 m0, s50, 49152
    s_add_u32 s48, s7, 8192
    s_add_u32 s48, s48, s51
    buffer_load_dwordx4 v212, s[40:43], s48 offen sc1 lds
    buffer_load_dwordx4 v212, s[40:43], s48 offen offset:1024 sc1 lds
    buffer_load_dwordx4 v213, s[40:43], s48 offen offset:2048 sc1 lds
    buffer_load_dwordx4 v213, s[40:43], s48 offen offset:3072 sc1 lds
    s_add_u32 s55, s55, 131072
    s_mov_b32 exec_lo, 0xff
    s_mov_b32 exec_hi, 0
    buffer_load_dword v222, v225, s[40:43], s55 offen offset:0 sc1
    s_mov_b64 exec, -1
    s_waitcnt vmcnt(13)
    s_barrier
    s_add_u32 m0, s22, 98304
    s_cmp_le_u32 s18, 2
    s_cselect_b32 s19, 1835008, 0
    s_cselect_b32 s51, 8192, 0
    s_add_u32 s61, s0, 3670016
    s_add_u32 s61, s61, s19
    s_mov_b32 s49, s61
    buffer_load_dwordx4 v214, s[36:39], s49 offen  lds
    buffer_load_dwordx4 v215, s[36:39], s49 offen offset:1024  lds
    s_add_u32 m0, s22, 106496
    s_xor_b32 s49, s61, 128
    buffer_load_dwordx4 v214, s[36:39], s49 offen  lds
    buffer_load_dwordx4 v215, s[36:39], s49 offen offset:1024  lds
    s_add_u32 m0, s22, 114688
    s_xor_b32 s49, s61, 256
    buffer_load_dwordx4 v214, s[36:39], s49 offen  lds
    buffer_load_dwordx4 v215, s[36:39], s49 offen offset:1024  lds
    s_add_u32 m0, s22, 122880
    s_xor_b32 s49, s61, 384
    buffer_load_dwordx4 v214, s[36:39], s49 offen  lds
    buffer_load_dwordx4 v215, s[36:39], s49 offen offset:1024  lds
    s_add_u32 m0, s50, 98304
    s_add_u32 s48, s7, 16384
    s_add_u32 s48, s48, s51
    buffer_load_dwordx4 v212, s[40:43], s48 offen sc1 lds
    buffer_load_dwordx4 v212, s[40:43], s48 offen offset:1024 sc1 lds
    buffer_load_dwordx4 v213, s[40:43], s48 offen offset:2048 sc1 lds
    buffer_load_dwordx4 v213, s[40:43], s48 offen offset:3072 sc1 lds
    s_waitcnt vmcnt(46)
    s_lshl_b32 s52, s62, 7
    s_add_u32 s52, s52, 31850496
    s_mov_b32 exec_hi, 0
    buffer_store_dword v220, v234, s[40:43], s52 offen offset:0 sc1
    s_mov_b64 exec, -1
    s_waitcnt vmcnt(14)
    s_barrier
    s_add_u32 m0, s22, 0
    s_cmp_le_u32 s18, 0
    s_cselect_b32 s19, 1835008, 0
    s_cselect_b32 s51, 8192, 0
    s_add_u32 s61, s0, 65536
    s_add_u32 s61, s61, s19
    s_mov_b32 s49, s61
    buffer_load_dwordx4 v214, s[36:39], s49 offen  lds
    buffer_load_dwordx4 v215, s[36:39], s49 offen offset:1024  lds
    s_add_u32 m0, s22, 8192
    s_xor_b32 s49, s61, 128
    buffer_load_dwordx4 v214, s[36:39], s49 offen  lds
    buffer_load_dwordx4 v215, s[36:39], s49 offen offset:1024  lds
    s_add_u32 m0, s22, 16384
    s_xor_b32 s49, s61, 256
    buffer_load_dwordx4 v214, s[36:39], s49 offen  lds
    buffer_load_dwordx4 v215, s[36:39], s49 offen offset:1024  lds
    s_add_u32 m0, s22, 24576
    s_xor_b32 s49, s61, 384
    buffer_load_dwordx4 v214, s[36:39], s49 offen  lds
    buffer_load_dwordx4 v215, s[36:39], s49 offen offset:1024  lds
    s_waitcnt vmcnt(21)
    s_mov_b32 exec_lo, 0xff
    s_mov_b32 exec_hi, 0
    s_mov_b32 s63, 0
PL14p:
    v_cmp_ne_u32 vcc, s21, v222
    s_cbranch_vccz PL14d
    s_sleep 1
    buffer_load_dword v222, v225, s[40:43], s55 offen offset:0 sc1
    s_add_u32 s63, s63, 1
    s_cmp_lt_u32 s63, 262144
    s_waitcnt vmcnt(0)
    s_cbranch_scc1 PL14p
PL14d:
    s_mov_b64 exec, -1
    s_add_u32 m0, s50, 0
    s_add_u32 s48, s7, 32768
    s_add_u32 s48, s48, s51
    buffer_load_dwordx4 v212, s[40:43], s48 offen sc1 lds
    buffer_load_dwordx4 v212, s[40:43], s48 offen offset:1024 sc1 lds
    buffer_load_dwordx4 v213, s[40:43], s48 offen offset:2048 sc1 lds
    buffer_load_dwordx4 v213, s[40:43], s48 offen offset:3072 sc1 lds
    s_waitcnt vmcnt(13)
    s_barrier
    s_add_u32 m0, s22, 49152
    s_cmp_le_u32 s18, 1
    s_cselect_b32 s19, 1835008, 0
    s_cselect_b32 s51, 8192, 0
    s_add_u32 s61, s0, 1900544
    s_add_u32 s61, s61, s19
    s_mov_b32 s49, s61
    buffer_load_dwordx4 v214, s[36:39], s49 offen  lds
    buffer_load_dwordx4 v215, s[36:39], s49 offen offset:1024  lds
    s_add_u32 m0, s22, 57344
    s_xor_b32 s49, s61, 128
    buffer_load_dwordx4 v214, s[36:39], s49 offen  lds
    buffer_load_dwordx4 v215, s[36:39], s49 offen offset:1024  lds
    s_add_u32 m0, s22, 65536
    s_xor_b32 s49, s61, 256
    buffer_load_dwordx4 v214, s[36:39], s49 offen  lds
    buffer_load_dwordx4 v215, s[36:39], s49 offen offset:1024  lds
    s_add_u32 m0, s22, 73728
    s_xor_b32 s49, s61, 384
    buffer_load_dwordx4 v214, s[36:39], s49 offen  lds
    buffer_load_dwordx4 v215, s[36:39], s49 offen offset:1024  lds
    s_add_u32 m0, s50, 49152
    s_add_u32 s48, s7, 40960
    s_add_u32 s48, s48, s51
    buffer_load_dwordx4 v212, s[40:43], s48 offen sc1 lds
    buffer_load_dwordx4 v212, s[40:43], s48 offen offset:1024 sc1 lds
    buffer_load_dwordx4 v213, s[40:43], s48 offen offset:2048 sc1 lds
    buffer_load_dwordx4 v213, s[40:43], s48 offen offset:3072 sc1 lds
    s_add_u32 s1, s1, 262144
    s_mov_b32 exec_lo, 0xffffffff
    s_mov_b32 exec_hi, 0
    buffer_load_dword v222, v223, s[40:43], s1 offen offset:0 sc1
    s_mov_b64 exec, -1
    s_waitcnt vmcnt(13)
    s_barrier
    s_add_u32 m0, s22, 98304
    s_cmp_le_u32 s18, 2
    s_cselect_b32 s19, 1835008, 0
    s_cselect_b32 s51, 8192, 0
    s_add_u32 s61, s0, 3735552
    s_add_u32 s61, s61, s19
    s_mov_b32 s49, s61
    buffer_load_dwordx4 v214, s[36:39], s49 offen  lds
    buffer_load_dwordx4 v215, s[36:39], s49 offen offset:1024  lds
    s_add_u32 m0, s22, 106496
    s_xor_b32 s49, s61, 128
    buffer_load_dwordx4 v214, s[36:39], s49 offen  lds
    buffer_load_dwordx4 v215, s[36:39], s49 offen offset:1024  lds
    s_add_u32 m0, s22, 114688
    s_xor_b32 s49, s61, 256
    buffer_load_dwordx4 v214, s[36:39], s49 offen  lds
    buffer_load_dwordx4 v215, s[36:39], s49 offen offset:1024  lds
    s_add_u32 m0, s22, 122880
    s_xor_b32 s49, s61, 384
    buffer_load_dwordx4 v214, s[36:39], s49 offen  lds
    buffer_load_dwordx4 v215, s[36:39], s49 offen offset:1024  lds
    s_add_u32 m0, s50, 98304
    s_add_u32 s48, s7, 49152
    s_add_u32 s48, s48, s51
    buffer_load_dwordx4 v212, s[40:43], s48 offen sc1 lds
    buffer_load_dwordx4 v212, s[40:43], s48 offen offset:1024 sc1 lds
    buffer_load_dwordx4 v213, s[40:43], s48 offen offset:2048 sc1 lds
    buffer_load_dwordx4 v213, s[40:43], s48 offen offset:3072 sc1 lds
    s_waitcnt vmcnt(13)
    s_barrier
    s_add_u32 m0, s22, 0
    s_cmp_le_u32 s18, 0
    s_cselect_b32 s19, 1835008, 0
    s_cselect_b32 s51, 8192, 0
    s_add_u32 s61, s0, 131072
    s_add_u32 s61, s61, s19
    s_mov_b32 s49, s61
    buffer_load_dwordx4 v214, s[36:39], s49 offen  lds
    buffer_load_dwordx4 v215, s[36:39], s49 offen offset:1024  lds
    s_add_u32 m0, s22, 8192
    s_xor_b32 s49, s61, 128
    buffer_load_dwordx4 v214, s[36:39], s49 offen  lds
    buffer_load_dwordx4 v215, s[36:39], s49 offen offset:1024  lds
    s_add_u32 m0, s22, 16384
    s_xor_b32 s49, s61, 256
    buffer_load_dwordx4 v214, s[36:39], s49 offen  lds
    buffer_load_dwordx4 v215, s[36:39], s49 offen offset:1024  lds
    s_add_u32 m0, s22, 24576
    s_xor_b32 s49, s61, 384
    buffer_load_dwordx4 v214, s[36:39], s49 offen  lds
    buffer_load_dwordx4 v215, s[36:39], s49 offen offset:1024  lds
    s_waitcnt vmcnt(20)
    s_mov_b32 exec_lo, 0xffffffff
    s_mov_b32 exec_hi, 0
    s_mov_b32 s63, 0
PL15p:
    v_cmp_ne_u32 vcc, s21, v222
    s_cbranch_vccz PL15d
    s_sleep 1
    buffer_load_dword v222, v223, s[40:43], s1 offen offset:0 sc1
    s_add_u32 s63, s63, 1
    s_cmp_lt_u32 s63, 262144
    s_waitcnt vmcnt(0)
    s_cbranch_scc1 PL15p
PL15d:
    s_mov_b64 exec, -1
    s_add_u32 m0, s50, 0
    s_add_u32 s48, s7, 65536
    s_add_u32 s48, s48, s51
    buffer_load_dwordx4 v212, s[40:43], s48 offen sc1 lds
    buffer_load_dwordx4 v212, s[40:43], s48 offen offset:1024 sc1 lds
    buffer_load_dwordx4 v213, s[40:43], s48 offen offset:2048 sc1 lds
    buffer_load_dwordx4 v213, s[40:43], s48 offen offset:3072 sc1 lds
    s_lshl_b32 s54, s5, 13
    s_lshl_b32 s52, s3, 11
    s_add_u32 s54, s54, s52
    s_add_u32 s54, s54, 31850496
    s_mov_b32 exec_lo, 0xffff
    s_mov_b32 exec_hi, 0
    buffer_load_dword v222, v219, s[40:43], s54 offen offset:0 sc1
    s_mov_b64 exec, -1
    s_waitcnt vmcnt(13)
    s_barrier
    s_add_u32 m0, s22, 49152
    s_cmp_le_u32 s18, 1
    s_cselect_b32 s19, 1835008, 0
    s_cselect_b32 s51, 8192, 0
    s_add_u32 s61, s0, 1966080
    s_add_u32 s61, s61, s19
    s_mov_b32 s49, s61
    buffer_load_dwordx4 v214, s[36:39], s49 offen  lds
    buffer_load_dwordx4 v215, s[36:39], s49 offen offset:1024  lds
    s_add_u32 m0, s22, 57344
    s_xor_b32 s49, s61, 128
    buffer_load_dwordx4 v214, s[36:39], s49 offen  lds
    buffer_load_dwordx4 v215, s[36:39], s49 offen offset:1024  lds
    s_add_u32 m0, s22, 65536
    s_xor_b32 s49, s61, 256
    buffer_load_dwordx4 v214, s[36:39], s49 offen  lds
    buffer_load_dwordx4 v215, s[36:39], s49 offen offset:1024  lds
    s_add_u32 m0, s22, 73728
    s_xor_b32 s49, s61, 384
    buffer_load_dwordx4 v214, s[36:39], s49 offen  lds
    buffer_load_dwordx4 v215, s[36:39], s49 offen offset:1024  lds
    s_add_u32 m0, s50, 49152
    s_add_u32 s48, s7, 73728
    s_add_u32 s48, s48, s51
    buffer_load_dwordx4 v212, s[40:43], s48 offen sc1 lds
    buffer_load_dwordx4 v212, s[40:43], s48 offen offset:1024 sc1 lds
    buffer_load_dwordx4 v213, s[40:43], s48 offen offset:2048 sc1 lds
    buffer_load_dwordx4 v213, s[40:43], s48 offen offset:3072 sc1 lds
    s_mov_b32 s2, 0
    s_getpc_b64 s[52:53]
PC16:
    s_add_u32 s52, s52, C_tail-PC16
    s_addc_u32 s53, s53, (C_tail-PC16)>>32
    v_lshlrev_b32 v250, 7, v2
    s_lshl_b32 s63, s2, 13
    v_add_u32 v250, s63, v250
    v_min_u32 v250, K_end-C_tail-68, v250
    global_load_dword v250, v250, s[52:53]
    s_waitcnt vmcnt(14)
    s_barrier
    s_add_u32 m0, s22, 98304
    s_cmp_le_u32 s18, 2
    s_cselect_b32 s19, 1835008, 0
    s_cselect_b32 s51, 8192, 0
    s_add_u32 s61, s0, 3801088
    s_add_u32 s61, s61, s19
    s_mov_b32 s49, s61
    buffer_load_dwordx4 v214, s[36:39], s49 offen  lds
    buffer_load_dwordx4 v215, s[36:39], s49 offen offset:1024  lds
    s_add_u32 m0, s22, 106496
    s_xor_b32 s49, s61, 128
    buffer_load_dwordx4 v214, s[36:39], s49 offen  lds
    buffer_load_dwordx4 v215, s[36:39], s49 offen offset:1024  lds
    s_add_u32 m0, s22, 114688
    s_xor_b32 s49, s61, 256
    buffer_load_dwordx4 v214, s[36:39], s49 offen  lds
    buffer_load_dwordx4 v215, s[36:39], s49 offen offset:1024  lds
    s_add_u32 m0, s22, 122880
    s_xor_b32 s49, s61, 384
    buffer_load_dwordx4 v214, s[36:39], s49 offen  lds
    buffer_load_dwordx4 v215, s[36:39], s49 offen offset:1024  lds
    s_add_u32 m0, s50, 98304
    s_add_u32 s48, s7, 81920
    s_add_u32 s48, s48, s51
    buffer_load_dwordx4 v212, s[40:43], s48 offen sc1 lds
    buffer_load_dwordx4 v212, s[40:43], s48 offen offset:1024 sc1 lds
    buffer_load_dwordx4 v213, s[40:43], s48 offen offset:2048 sc1 lds
    buffer_load_dwordx4 v213, s[40:43], s48 offen offset:3072 sc1 lds
    s_waitcnt vmcnt(25)
    s_mov_b32 exec_lo, 0xffff
    s_mov_b32 exec_hi, 0
    s_mov_b32 s63, 0
PL17p:
    v_cmp_ne_u32 vcc, s21, v222
    s_cbranch_vccz PL17d
    s_sleep 1
    buffer_load_dword v222, v219, s[40:43], s54 offen offset:0 sc1
    s_add_u32 s63, s63, 1
    s_cmp_lt_u32 s63, 262144
    s_waitcnt vmcnt(0)
    s_cbranch_scc1 PL17p
PL17d:
    s_mov_b64 exec, -1
    s_lshl_b32 s57, s5, 6
    s_lshl_b32 s53, s3, 4
    s_add_u32 s57, s57, s53
    s_lshl_b32 s57, s57, 12
    s_lshl_b32 s53, s4, 8
    s_add_u32 s57, s57, s53
    s_add_u32 s57, s57, 25165824
    s_add_u32 m0, s50, 147456
    s_nop 0
    buffer_load_dwordx4 v226, s[40:43], s57 offen sc1 lds
    s_add_u32 s57, s57, 16384
    s_add_u32 m0, s50, 148480
    s_nop 0
    buffer_load_dwordx4 v227, s[40:43], s57 offen sc1 lds
    s_add_u32 s57, s57, 16384
    s_add_u32 m0, s50, 149504
    s_nop 0
    buffer_load_dwordx4 v226, s[40:43], s57 offen sc1 lds
    s_add_u32 s57, s57, 16384
    s_add_u32 m0, s50, 150528
    s_nop 0
    buffer_load_dwordx4 v227, s[40:43], s57 offen sc1 lds
    s_add_u32 s57, s57, 16384
    s_waitcnt vmcnt(17)
    s_barrier
    s_add_u32 m0, s22, 0
    s_and_b32 s51, s5, 3
    s_mul_i32 s61, s51, 917504
    s_add_u32 s61, s61, s20
    s_add_u32 s61, s61, 196608
    s_mov_b32 s49, s61
    buffer_load_dwordx4 v214, s[36:39], s49 offen  lds
    buffer_load_dwordx4 v215, s[36:39], s49 offen offset:1024  lds
    s_add_u32 m0, s22, 8192
    s_xor_b32 s49, s61, 128
    buffer_load_dwordx4 v214, s[36:39], s49 offen  lds
    buffer_load_dwordx4 v215, s[36:39], s49 offen offset:1024  lds
    s_add_u32 m0, s22, 16384
    s_xor_b32 s49, s61, 256
    buffer_load_dwordx4 v214, s[36:39], s49 offen  lds
    buffer_load_dwordx4 v215, s[36:39], s49 offen offset:1024  lds
    s_add_u32 m0, s22, 24576
    s_xor_b32 s49, s61, 384
    buffer_load_dwordx4 v214, s[36:39], s49 offen  lds
    buffer_load_dwordx4 v215, s[36:39], s49 offen offset:1024  lds
    s_add_u32 m0, s50, 0
    s_add_u32 s48, s7, 98304
    buffer_load_dwordx4 v212, s[40:43], s48 offen sc1 lds
    buffer_load_dwordx4 v212, s[40:43], s48 offen offset:1024 sc1 lds
    buffer_load_dwordx4 v213, s[40:43], s48 offen offset:2048 sc1 lds
    buffer_load_dwordx4 v213, s[40:43], s48 offen offset:3072 sc1 lds
    s_waitcnt vmcnt(16)
    s_barrier
    s_add_u32 m0, s22, 49152
    s_add_u32 s49, s20, 3866624
    buffer_load_dwordx4 v214, s[36:39], s49 offen  lds
    buffer_load_dwordx4 v215, s[36:39], s49 offen offset:1024  lds
    s_add_u32 m0, s50, 49152
    s_add_u32 s48, s60, 106496
    buffer_load_dwordx4 v212, s[40:43], s48 offen sc1 lds
    buffer_load_dwordx4 v212, s[40:43], s48 offen offset:1024 sc1 lds
    buffer_load_dwordx4 v213, s[40:43], s48 offen offset:2048 sc1 lds
    buffer_load_dwordx4 v213, s[40:43], s48 offen offset:3072 sc1 lds
    s_add_u32 m0, s22, 73728
    s_add_u32 s49, s20, 4784128
    buffer_load_dwordx4 v214, s[36:39], s49 offen  lds
    buffer_load_dwordx4 v215, s[36:39], s49 offen offset:1024  lds
    s_add_u32 m0, s50, 73728
    s_add_u32 s48, s60, 108544
    buffer_load_dwordx4 v212, s[40:43], s48 offen sc1 lds
    buffer_load_dwordx4 v212, s[40:43], s48 offen offset:1024 sc1 lds
    buffer_load_dwordx4 v213, s[40:43], s48 offen offset:2048 sc1 lds
    buffer_load_dwordx4 v213, s[40:43], s48 offen offset:3072 sc1 lds
    s_waitcnt vmcnt(12)
    s_barrier
    s_add_u32 m0, s22, 98304
    s_add_u32 s49, s20, 5701632
    buffer_load_dwordx4 v214, s[36:39], s49 offen  lds
    buffer_load_dwordx4 v215, s[36:39], s49 offen offset:1024  lds
    s_add_u32 m0, s50, 98304
    s_add_u32 s48, s60, 110592
    buffer_load_dwordx4 v212, s[40:43], s48 offen sc1 lds
    buffer_load_dwordx4 v212, s[40:43], s48 offen offset:1024 sc1 lds
    buffer_load_dwordx4 v213, s[40:43], s48 offen offset:2048 sc1 lds
    buffer_load_dwordx4 v213, s[40:43], s48 offen offset:3072 sc1 lds
    s_add_u32 m0, s22, 122880
    s_add_u32 s49, s20, 6619136
    buffer_load_dwordx4 v214, s[36:39], s49 offen  lds
    buffer_load_dwordx4 v215, s[36:39], s49 offen offset:1024  lds
    s_add_u32 m0, s50, 122880
    s_add_u32 s48, s60, 112640
    buffer_load_dwordx4 v212, s[40:43], s48 offen sc1 lds
    buffer_load_dwordx4 v212, s[40:43], s48 offen offset:1024 sc1 lds
    buffer_load_dwordx4 v213, s[40:43], s48 offen offset:2048 sc1 lds
    buffer_load_dwordx4 v213, s[40:43], s48 offen offset:3072 sc1 lds
    s_waitcnt vmcnt(18)
    s_barrier
    s_add_u32 m0, s50, 16384
    s_nop 0
    buffer_load_dwordx4 v216, s[32:35], s23 offen lds
    s_add_u32 s23, s23, 16384
    s_add_u32 m0, s50, 17408
    s_nop 0
    buffer_load_dwordx4 v216, s[32:35], s23 offen lds
    s_add_u32 s23, s23, 16384
    s_add_u32 m0, s50, 18432
    s_nop 0
    buffer_load_dwordx4 v216, s[32:35], s23 offen lds
    s_add_u32 s23, s23, 16384
    s_add_u32 m0, s50, 19456
    s_nop 0
    buffer_load_dwordx4 v216, s[32:35], s23 offen lds
    s_add_u32 s23, s23, 16384
    s_waitcnt vmcnt(4)
    s_barrier
    s_barrier
    s_barrier
    s_waitcnt vmcnt(0)
    s_barrier
    s_endpgm
C_start:
    s_lshr_b32 s48, s3, 1
    s_and_b32 s49, s3, 1
    s_lshl_b32 s50, s6, 3
    s_lshl_b32 s51, s3, 1
    s_add_u32 s50, s50, s51
    s_lshl_b32 s51, s50, 11
    v_lshlrev_b32 v248, 4, v2
    v_mov_b32 v5, 0
    v_and_b32 v3, 15, v2
    v_lshrrev_b32 v4, 4, v2
    s_waitcnt lgkmcnt(0)
    s_mov_b32 s32, s8
    s_and_b32 s33, s9, 0xffff
    s_mov_b32 s34, 4194304
    s_mov_b32 s35, 0x20000
    buffer_load_dwordx4 v[128:131], v248, s[32:35], s51 offen offset:0
    buffer_load_dwordx4 v[132:135], v248, s[32:35], s51 offen offset:1024
    buffer_load_dwordx4 v[136:139], v248, s[32:35], s51 offen offset:2048
    buffer_load_dwordx4 v[140:143], v248, s[32:35], s51 offen offset:3072
    s_mov_b32 s40, s30
    s_and_b32 s41, s31, 0xffff
    s_mov_b32 s42, 268435456
    s_mov_b32 s43, 0x20000
    s_mov_b32 s52, 31457280
    s_cmp_eq_u32 s50, 0
    s_cselect_b32 s52, s52, 268435456
    buffer_load_dword v180, v5, s[40:43], s52 offen sc1
    v_lshrrev_b32 v5, 1, v3
    v_xor_b32 v5, v5, v4
    v_xor_b32 v6, 4, v5
    s_lshl_b32 s52, s48, 13
    s_add_u32 s52, s52, 45056
    v_lshlrev_b32 v7, 7, v3
    v_add_u32 v7, s52, v7
    v_lshl_add_u32 v10, v5, 4, v7
    v_lshl_add_u32 v11, v6, 4, v7
    v_lshrrev_b32 v5, 2, v3
    v_lshl_add_u32 v5, v4, 3, v5
    v_mul_u32_u24 v5, 448, v5
    v_and_b32 v6, 3, v2
    v_lshl_add_u32 v5, v6, 3, v5
    v_add_u32 v5, 61440, v5
    v_and_b32 v6, 1, v4
    v_xor_b32 v9, s49, v6
    v_lshl_add_u32 v9, v9, 5, v5
    s_lshl_b32 s52, s49, 8
    v_add_u32 v5, s52, v5
    v_lshlrev_b32 v6, 5, v6
    v_add_u32 v12, v5, v6
    v_sub_u32 v13, v5, v6
    v_mov_b32 v16, 0
    v_mov_b32 v17, 0
    v_pk_mov_b32 v[18:19], v[16:17], v[16:17]
    v_pk_mov_b32 v[20:21], v[16:17], v[16:17]
    v_pk_mov_b32 v[22:23], v[16:17], v[16:17]
    v_pk_mov_b32 v[24:25], v[16:17], v[16:17]
    v_pk_mov_b32 v[26:27], v[16:17], v[16:17]
    v_pk_mov_b32 v[28:29], v[16:17], v[16:17]
    v_pk_mov_b32 v[30:31], v[16:17], v[16:17]
    v_pk_mov_b32 v[32:33], v[16:17], v[16:17]
    v_pk_mov_b32 v[34:35], v[16:17], v[16:17]
    v_pk_mov_b32 v[36:37], v[16:17], v[16:17]
    v_pk_mov_b32 v[38:39], v[16:17], v[16:17]
    v_pk_mov_b32 v[40:41], v[16:17], v[16:17]
    v_pk_mov_b32 v[42:43], v[16:17], v[16:17]
    v_pk_mov_b32 v[44:45], v[16:17], v[16:17]
    v_pk_mov_b32 v[46:47], v[16:17], v[16:17]
    v_pk_mov_b32 v[48:49], v[16:17], v[16:17]
    v_pk_mov_b32 v[50:51], v[16:17], v[16:17]
    v_pk_mov_b32 v[52:53], v[16:17], v[16:17]
    v_pk_mov_b32 v[54:55], v[16:17], v[16:17]
    v_pk_mov_b32 v[56:57], v[16:17], v[16:17]
    v_pk_mov_b32 v[58:59], v[16:17], v[16:17]
    v_pk_mov_b32 v[60:61], v[16:17], v[16:17]
    v_pk_mov_b32 v[62:63], v[16:17], v[16:17]
    v_pk_mov_b32 v[64:65], v[16:17], v[16:17]
    v_pk_mov_b32 v[66:67], v[16:17], v[16:17]
    v_pk_mov_b32 v[68:69], v[16:17], v[16:17]
    v_pk_mov_b32 v[70:71], v[16:17], v[16:17]
    v_pk_mov_b32 v[72:73], v[16:17], v[16:17]
    v_pk_mov_b32 v[74:75], v[16:17], v[16:17]
    v_pk_mov_b32 v[76:77], v[16:17], v[16:17]
    v_pk_mov_b32 v[78:79], v[16:17], v[16:17]
    v_pk_mov_b32 v[80:81], v[16:17], v[16:17]
    v_pk_mov_b32 v[82:83], v[16:17], v[16:17]
    v_pk_mov_b32 v[84:85], v[16:17], v[16:17]
    v_pk_mov_b32 v[86:87], v[16:17], v[16:17]
    v_pk_mov_b32 v[88:89], v[16:17], v[16:17]
    v_pk_mov_b32 v[90:91], v[16:17], v[16:17]
    v_pk_mov_b32 v[92:93], v[16:17], v[16:17]
    v_pk_mov_b32 v[94:95], v[16:17], v[16:17]
    v_pk_mov_b32 v[96:97], v[16:17], v[16:17]
    v_pk_mov_b32 v[98:99], v[16:17], v[16:17]
    v_pk_mov_b32 v[100:101], v[16:17], v[16:17]
    v_pk_mov_b32 v[102:103], v[16:17], v[16:17]
    v_pk_mov_b32 v[104:105], v[16:17], v[16:17]
    v_pk_mov_b32 v[106:107], v[16:17], v[16:17]
    v_pk_mov_b32 v[108:109], v[16:17], v[16:17]
    v_pk_mov_b32 v[110:111], v[16:17], v[16:17]
    v_pk_mov_b32 v[112:113], v[16:17], v[16:17]
    v_pk_mov_b32 v[114:115], v[16:17], v[16:17]
    v_pk_mov_b32 v[116:117], v[16:17], v[16:17]
    v_pk_mov_b32 v[118:119], v[16:17], v[16:17]
    v_pk_mov_b32 v[120:121], v[16:17], v[16:17]
    v_pk_mov_b32 v[122:123], v[16:17], v[16:17]
    v_pk_mov_b32 v[124:125], v[16:17], v[16:17]
    v_pk_mov_b32 v[126:127], v[16:17], v[16:17]
    s_lshl_b32 s52, s4, 7
    s_lshl_b32 s53, s48, 6
    s_add_u32 s52, s52, s53
    v_lshrrev_b32 v5, 2, v2
    v_add_u32 v5, s52, v5
    v_lshlrev_b32 v5, 11, v5
    v_and_b32 v6, 3, v2
    v_lshl_add_u32 v5, v6, 4, v5
    s_lshl_b32 s52, s5, 7
    s_lshl_b32 s53, s49, 6
    s_add_u32 s52, s52, s53
    v_add_u32 v14, s52, v5
    v_lshlrev_b32 v246, 4, v4
    v_add_u32 v246, 161792, v246
    s_lshl_b32 s52, s49, 6
    v_add_u32 v245, s52, v246
    s_lshl_b32 s52, s49, 9
    v_add_u32 v246, s52, v246
    s_lshl_b32 s52, s48, 9
    s_add_u32 s52, s52, 162816
    v_lshlrev_b32 v247, 3, v3
    v_add_u32 v247, s52, v247
    v_and_b32 v249, 47, v2
    v_lshlrev_b32 v249, 4, v249
    s_lshl_b32 s53, s49, 8
    v_add_u32 v249, s53, v249
    v_and_b32 v5, 1, v4
    v_mul_u32_u24 v5, 114688, v5
    v_add_u32 v249, v249, v5
    s_lshl_b32 s53, s48, 13
    s_add_u32 s53, s53, 16384
    v_lshlrev_b32 v5, 7, v3
    v_add_u32 v5, s53, v5
    v_and_b32 v6, 1, v4
    v_lshl_add_u32 v5, v6, 3, v5
    v_lshrrev_b32 v6, 1, v4
    s_lshl_b32 s53, s49, 2
    v_add_u32 v6, s53, v6
    v_and_b32 v7, 7, v3
    v_xor_b32 v6, v6, v7
    v_lshl_add_u32 v250, v6, 4, v5
    v_xor_b32 v6, 2, v6
    v_lshl_add_u32 v251, v6, 4, v5
    s_lshl_b32 s52, s48, 13
    v_add_u32 v240, s52, v248
    s_lshl_b32 s52, s49, 10
    v_add_u32 v243, s52, v240
    v_add_u32 v244, 98304, v243
    v_lshrrev_b32 v6, 3, v2
    v_and_b32 v6, 3, v6
    s_lshl_b32 s52, s49, 1
    v_xor_b32 v6, s52, v6
    v_lshrrev_b32 v5, 2, v3
    v_and_b32 v8, 16, v2
    v_add_u32 v5, v5, v8
    v_lshrrev_b32 v8, 5, v2
    v_lshl_add_u32 v5, v8, 3, v5
    v_lshlrev_b32 v5, 7, v5
    v_and_b32 v8, 3, v2
    v_lshl_add_u32 v5, v8, 3, v5
    v_add_u32 v5, 16384, v5
    v_lshl_add_u32 v241, v6, 5, v5
    v_xor_b32 v6, 1, v6
    v_lshl_add_u32 v242, v6, 5, v5
    s_lshl_b32 s62, s6, 2
    s_add_u32 s62, s62, s3
    s_lshl_b32 s62, s62, 7
    s_lshl_b32 s60, s4, 3
    s_lshl_b32 s53, s48, 2
    s_add_u32 s60, s60, s53
    s_mul_i32 s60, s60, 112
    s_add_u32 s61, s60, s5
    s_add_u32 s61, s61, 96
    s_lshl_b32 s61, s61, 10
    s_add_u32 s1, s61, 8388608
    s_lshl_b32 s53, s5, 1
    s_add_u32 s60, s60, s53
    s_add_u32 s60, s60, s49
    s_lshl_b32 s60, s60, 10
    s_add_u32 s0, s60, 8388608
    v_lshlrev_b32 v5, 2, v2
    s_waitcnt vmcnt(0)
    s_cmp_lg_u32 s50, 0
    s_cbranch_scc1 C_ne1
    s_mov_b32 s52, 1664525
    v_mul_lo_u32 v180, v180, s52
    v_add_u32 v180, 1013904223, v180
    v_mov_b32 v181, 1
    s_mov_b32 s52, 31457280
    s_mov_b32 s44, s28
    s_and_b32 s45, s29, 0xffff
    s_mov_b32 s46, 256
    s_mov_b32 s47, 0x20000
    s_mov_b64 exec, 1
    buffer_store_dword v180, v5, s[40:43], s52 offen sc1
    buffer_store_dwordx2 v[180:181], v5, s[44:47], 0 offen sc1
    s_mov_b64 exec, -1
C_ne1:
    v_lshlrev_b32 v144, 16, v128
    v_and_b32 v145, 0xffff0000, v128
    v_lshlrev_b32 v146, 16, v129
    v_and_b32 v147, 0xffff0000, v129
    v_lshlrev_b32 v148, 16, v130
    v_and_b32 v149, 0xffff0000, v130
    v_lshlrev_b32 v150, 16, v131
    v_and_b32 v151, 0xffff0000, v131
    v_lshlrev_b32 v152, 16, v132
    v_and_b32 v153, 0xffff0000, v132
    v_lshlrev_b32 v154, 16, v133
    v_and_b32 v155, 0xffff0000, v133
    v_lshlrev_b32 v156, 16, v134
    v_and_b32 v157, 0xffff0000, v134
    v_lshlrev_b32 v158, 16, v135
    v_and_b32 v159, 0xffff0000, v135
    v_lshlrev_b32 v160, 16, v136
    v_and_b32 v161, 0xffff0000, v136
    v_lshlrev_b32 v162, 16, v137
    v_and_b32 v163, 0xffff0000, v137
    v_lshlrev_b32 v164, 16, v138
    v_and_b32 v165, 0xffff0000, v138
    v_lshlrev_b32 v166, 16, v139
    v_and_b32 v167, 0xffff0000, v139
    v_lshlrev_b32 v168, 16, v140
    v_and_b32 v169, 0xffff0000, v140
    v_lshlrev_b32 v170, 16, v141
    v_and_b32 v171, 0xffff0000, v141
    v_lshlrev_b32 v172, 16, v142
    v_and_b32 v173, 0xffff0000, v142
    v_lshlrev_b32 v174, 16, v143
    v_and_b32 v175, 0xffff0000, v143
    v_pk_add_f32 v[182:183], v[144:145], v[146:147]
    v_pk_add_f32 v[184:185], v[148:149], v[150:151]
    v_pk_add_f32 v[186:187], v[152:153], v[154:155]
    v_pk_add_f32 v[188:189], v[156:157], v[158:159]
    v_pk_add_f32 v[182:183], v[182:183], v[184:185]
    v_pk_add_f32 v[186:187], v[186:187], v[188:189]
    v_pk_add_f32 v[182:183], v[182:183], v[186:187]
    v_add_f32 v176, v182, v183
    v_pk_add_f32 v[182:183], v[160:161], v[162:163]
    v_pk_add_f32 v[184:185], v[164:165], v[166:167]
    v_pk_add_f32 v[186:187], v[168:169], v[170:171]
    v_pk_add_f32 v[188:189], v[172:173], v[174:175]
    v_pk_add_f32 v[182:183], v[182:183], v[184:185]
    v_pk_add_f32 v[186:187], v[186:187], v[188:189]
    v_pk_add_f32 v[182:183], v[182:183], v[186:187]
    v_add_f32 v178, v182, v183
    s_nop 0
    v_add_f32_dpp v176, v176, v176 quad_perm:[1,0,3,2] row_mask:0xf bank_mask:0xf
    v_add_f32_dpp v178, v178, v178 quad_perm:[1,0,3,2] row_mask:0xf bank_mask:0xf
    s_nop 0
    v_add_f32_dpp v176, v176, v176 quad_perm:[2,3,0,1] row_mask:0xf bank_mask:0xf
    v_add_f32_dpp v178, v178, v178 quad_perm:[2,3,0,1] row_mask:0xf bank_mask:0xf
    s_nop 0
    v_add_f32_dpp v176, v176, v176 row_half_mirror row_mask:0xf bank_mask:0xf
    v_add_f32_dpp v178, v178, v178 row_half_mirror row_mask:0xf bank_mask:0xf
    s_nop 0
    v_add_f32_dpp v176, v176, v176 row_mirror row_mask:0xf bank_mask:0xf
    v_add_f32_dpp v178, v178, v178 row_mirror row_mask:0xf bank_mask:0xf
    s_nop 0
    v_readlane_b32 s52, v176, 0
    v_readlane_b32 s53, v176, 16
    v_readlane_b32 s54, v176, 32
    v_readlane_b32 s55, v176, 48
    v_readlane_b32 s56, v178, 0
    v_readlane_b32 s57, v178, 16
    v_readlane_b32 s58, v178, 32
    v_readlane_b32 s59, v178, 48
    s_nop 1
    v_mov_b32 v176, s52
    v_add_f32 v176, s53, v176
    v_add_f32 v176, s54, v176
    v_add_f32 v176, s55, v176
    v_mov_b32 v178, s56
    v_add_f32 v178, s57, v178
    v_add_f32 v178, s58, v178
    v_add_f32 v178, s59, v178
    v_mul_f32 v176, 0x3a800000, v176
    v_mul_f32 v178, 0x3a800000, v178
    v_sub_f32 v182, 0, v176
    v_sub_f32 v183, 0, v176
    v_sub_f32 v184, 0, v178
    v_sub_f32 v185, 0, v178
    v_pk_add_f32 v[144:145], v[144:145], v[182:183]
    v_pk_add_f32 v[160:161], v[160:161], v[184:185]
    v_pk_add_f32 v[146:147], v[146:147], v[182:183]
    v_pk_add_f32 v[162:163], v[162:163], v[184:185]
    v_pk_add_f32 v[148:149], v[148:149], v[182:183]
    v_pk_add_f32 v[164:165], v[164:165], v[184:185]
    v_pk_add_f32 v[150:151], v[150:151], v[182:183]
    v_pk_add_f32 v[166:167], v[166:167], v[184:185]
    v_pk_add_f32 v[152:153], v[152:153], v[182:183]
    v_pk_add_f32 v[168:169], v[168:169], v[184:185]
    v_pk_add_f32 v[154:155], v[154:155], v[182:183]
    v_pk_add_f32 v[170:171], v[170:171], v[184:185]
    v_pk_add_f32 v[156:157], v[156:157], v[182:183]
    v_pk_add_f32 v[172:173], v[172:173], v[184:185]
    v_pk_add_f32 v[158:159], v[158:159], v[182:183]
    v_pk_add_f32 v[174:175], v[174:175], v[184:185]
    v_pk_mul_f32 v[186:187], v[144:145], v[144:145]
    v_pk_mul_f32 v[188:189], v[160:161], v[160:161]
    v_pk_fma_f32 v[186:187], v[146:147], v[146:147], v[186:187]
    v_pk_fma_f32 v[188:189], v[162:163], v[162:163], v[188:189]
    v_pk_fma_f32 v[186:187], v[148:149], v[148:149], v[186:187]
    v_pk_fma_f32 v[188:189], v[164:165], v[164:165], v[188:189]
    v_pk_fma_f32 v[186:187], v[150:151], v[150:151], v[186:187]
    v_pk_fma_f32 v[188:189], v[166:167], v[166:167], v[188:189]
    v_pk_fma_f32 v[186:187], v[152:153], v[152:153], v[186:187]
    v_pk_fma_f32 v[188:189], v[168:169], v[168:169], v[188:189]
    v_pk_fma_f32 v[186:187], v[154:155], v[154:155], v[186:187]
    v_pk_fma_f32 v[188:189], v[170:171], v[170:171], v[188:189]
    v_pk_fma_f32 v[186:187], v[156:157], v[156:157], v[186:187]
    v_pk_fma_f32 v[188:189], v[172:173], v[172:173], v[188:189]
    v_pk_fma_f32 v[186:187], v[158:159], v[158:159], v[186:187]
    v_pk_fma_f32 v[188:189], v[174:175], v[174:175], v[188:189]
    v_add_f32 v177, v186, v187
    v_add_f32 v179, v188, v189
    s_nop 0
    v_add_f32_dpp v177, v177, v177 quad_perm:[1,0,3,2] row_mask:0xf bank_mask:0xf
    v_add_f32_dpp v179, v179, v179 quad_perm:[1,0,3,2] row_mask:0xf bank_mask:0xf
    s_nop 0
    v_add_f32_dpp v177, v177, v177 quad_perm:[2,3,0,1] row_mask:0xf bank_mask:0xf
    v_add_f32_dpp v179, v179, v179 quad_perm:[2,3,0,1] row_mask:0xf bank_mask:0xf
    s_nop 0
    v_add_f32_dpp v177, v177, v177 row_half_mirror row_mask:0xf bank_mask:0xf
    v_add_f32_dpp v179, v179, v179 row_half_mirror row_mask:0xf bank_mask:0xf
    s_nop 0
    v_add_f32_dpp v177, v177, v177 row_mirror row_mask:0xf bank_mask:0xf
    v_add_f32_dpp v179, v179, v179 row_mirror row_mask:0xf bank_mask:0xf
    s_nop 0
    v_readlane_b32 s52, v177, 0
    v_readlane_b32 s53, v177, 16
    v_readlane_b32 s54, v177, 32
    v_readlane_b32 s55, v177, 48
    v_readlane_b32 s56, v179, 0
    v_readlane_b32 s57, v179, 16
    v_readlane_b32 s58, v179, 32
    v_readlane_b32 s59, v179, 48
    s_nop 1
    v_mov_b32 v177, s52
    v_add_f32 v177, s53, v177
    v_add_f32 v177, s54, v177
    v_add_f32 v177, s55, v177
    v_mov_b32 v179, s56
    v_add_f32 v179, s57, v179
    v_add_f32 v179, s58, v179
    v_add_f32 v179, s59, v179
    v_mul_f32 v177, 0x3a800000, v177
    v_cvt_pk_bf16_f32 v176, v176, v176
    v_lshlrev_b32 v176, 16, v176
    v_cvt_pk_bf16_f32 v177, v177, v177
    v_lshlrev_b32 v177, 16, v177
    v_add_f32 v177, 0x3727c5ac, v177
    v_cvt_pk_bf16_f32 v177, v177, v177
    v_lshlrev_b32 v177, 16, v177
    v_sqrt_f32 v177, v177
    s_nop 0
    v_cvt_pk_bf16_f32 v177, v177, v177
    v_lshlrev_b32 v177, 16, v177
    v_mul_f32 v179, 0x3a800000, v179
    v_cvt_pk_bf16_f32 v178, v178, v178
    v_lshlrev_b32 v178, 16, v178
    v_cvt_pk_bf16_f32 v179, v179, v179
    v_lshlrev_b32 v179, 16, v179
    v_add_f32 v179, 0x3727c5ac, v179
    v_cvt_pk_bf16_f32 v179, v179, v179
    v_lshlrev_b32 v179, 16, v179
    v_sqrt_f32 v179, v179
    s_nop 0
    v_cvt_pk_bf16_f32 v179, v179, v179
    v_lshlrev_b32 v179, 16, v179
    s_lshl_b32 s51, s50, 3
    s_add_u32 s51, s51, 30408704
    s_mov_b64 exec, 1
    buffer_store_dwordx4 v[176:179], v5, s[40:43], s51 offen sc1
    s_mov_b64 exec, -1
    s_mov_b32 s52, 45056
    s_mov_b32 s53, 45056
    s_mov_b32 s55, 0
    s_barrier
    ds_read_b128 v[128:131], v10 offset:0
    ds_read_b128 v[132:135], v11 offset:0
    ds_read_b128 v[136:139], v10 offset:2048
    ds_read_b128 v[140:143], v11 offset:2048
    ds_read_b64_tr_b16 v[160:161], v13 offset:96
    ds_read_b64_tr_b16 v[162:163], v13 offset:1888
    ds_read_b64_tr_b16 v[164:165], v13 offset:14432
    ds_read_b64_tr_b16 v[166:167], v13 offset:16224
    ds_read_b64_tr_b16 v[200:201], v12 offset:0
    ds_read_b64_tr_b16 v[202:203], v12 offset:1792
    ds_read_b64_tr_b16 v[204:205], v12 offset:14336
    ds_read_b64_tr_b16 v[206:207], v12 offset:16128
    ds_read_b128 v[144:147], v10 offset:4096
    ds_read_b128 v[148:151], v11 offset:4096
    ds_read_b128 v[152:155], v10 offset:6144
    ds_read_b128 v[156:159], v11 offset:6144
    ds_read_b64_tr_b16 v[208:209], v13 offset:32
    ds_read_b64_tr_b16 v[210:211], v13 offset:1824
    ds_read_b64_tr_b16 v[212:213], v13 offset:14368
    ds_read_b64_tr_b16 v[214:215], v13 offset:16160
C_l1:
    s_waitcnt lgkmcnt(10)
    v_mfma_f32_16x16x32_bf16 v[16:19], v[200:203], v[128:131], v[16:19]
    ds_read_b64_tr_b16 v[216:217], v12 offset:64
    s_waitcnt lgkmcnt(9)
    v_mfma_f32_16x16x32_bf16 v[16:19], v[204:207], v[132:135], v[16:19]
    ds_read_b64_tr_b16 v[218:219], v12 offset:1856
    v_mfma_f32_16x16x32_bf16 v[20:23], v[200:203], v[136:139], v[20:23]
    ds_read_b64_tr_b16 v[220:221], v12 offset:14400
    v_mfma_f32_16x16x32_bf16 v[20:23], v[204:207], v[140:143], v[20:23]
    ds_read_b64_tr_b16 v[222:223], v12 offset:16192
    s_waitcnt lgkmcnt(11)
    v_mfma_f32_16x16x32_bf16 v[24:27], v[200:203], v[144:147], v[24:27]
    s_waitcnt lgkmcnt(10)
    v_mfma_f32_16x16x32_bf16 v[24:27], v[204:207], v[148:151], v[24:27]
    s_waitcnt lgkmcnt(9)
    v_mfma_f32_16x16x32_bf16 v[28:31], v[200:203], v[152:155], v[28:31]
    s_waitcnt lgkmcnt(8)
    v_mfma_f32_16x16x32_bf16 v[28:31], v[204:207], v[156:159], v[28:31]
    s_waitcnt lgkmcnt(6)
    v_mfma_f32_16x16x32_bf16 v[44:47], v[208:211], v[152:155], v[44:47]
    ds_read_b64_tr_b16 v[200:201], v12 offset:128
    s_waitcnt lgkmcnt(5)
    v_mfma_f32_16x16x32_bf16 v[44:47], v[212:215], v[156:159], v[44:47]
    ds_read_b64_tr_b16 v[202:203], v12 offset:1920
    v_mfma_f32_16x16x32_bf16 v[40:43], v[208:211], v[144:147], v[40:43]
    ds_read_b64_tr_b16 v[204:205], v12 offset:14464
    v_mfma_f32_16x16x32_bf16 v[40:43], v[212:215], v[148:151], v[40:43]
    ds_read_b64_tr_b16 v[206:207], v12 offset:16256
    v_mfma_f32_16x16x32_bf16 v[36:39], v[208:211], v[136:139], v[36:39]
    s_add_u32 s53, s53, 45056
    s_cmp_ge_u32 s53, 135168
    s_cselect_b32 s54, -90112, s52
    v_mfma_f32_16x16x32_bf16 v[36:39], v[212:215], v[140:143], v[36:39]
    s_cselect_b32 s53, 0, s53
    v_add_u32 v10, s54, v10
    v_mfma_f32_16x16x32_bf16 v[32:35], v[208:211], v[128:131], v[32:35]
    v_add_u32 v11, s54, v11
    v_mfma_f32_16x16x32_bf16 v[32:35], v[212:215], v[132:135], v[32:35]
    s_waitcnt lgkmcnt(6)
    v_mfma_f32_16x16x32_bf16 v[48:51], v[216:219], v[128:131], v[48:51]
    ds_read_b64_tr_b16 v[208:209], v13 offset:160
    s_waitcnt lgkmcnt(5)
    v_mfma_f32_16x16x32_bf16 v[48:51], v[220:223], v[132:135], v[48:51]
    ds_read_b64_tr_b16 v[210:211], v13 offset:1952
    v_mfma_f32_16x16x32_bf16 v[52:55], v[216:219], v[136:139], v[52:55]
    ds_read_b64_tr_b16 v[212:213], v13 offset:14496
    v_mfma_f32_16x16x32_bf16 v[52:55], v[220:223], v[140:143], v[52:55]
    ds_read_b64_tr_b16 v[214:215], v13 offset:16288
    v_mfma_f32_16x16x32_bf16 v[56:59], v[216:219], v[144:147], v[56:59]
    v_mfma_f32_16x16x32_bf16 v[56:59], v[220:223], v[148:151], v[56:59]
    v_add_u32 v12, s54, v12
    v_mfma_f32_16x16x32_bf16 v[60:63], v[216:219], v[152:155], v[60:63]
    v_add_u32 v13, s54, v13
    v_mfma_f32_16x16x32_bf16 v[60:63], v[220:223], v[156:159], v[60:63]
    v_mfma_f32_16x16x32_bf16 v[76:79], v[160:163], v[152:155], v[76:79]
    ds_read_b64_tr_b16 v[216:217], v9 offset:192
    v_mfma_f32_16x16x32_bf16 v[76:79], v[164:167], v[156:159], v[76:79]
    ds_read_b64_tr_b16 v[218:219], v9 offset:1984
    v_mfma_f32_16x16x32_bf16 v[72:75], v[160:163], v[144:147], v[72:75]
    ds_read_b64_tr_b16 v[220:221], v9 offset:14528
    v_mfma_f32_16x16x32_bf16 v[72:75], v[164:167], v[148:151], v[72:75]
    ds_read_b64_tr_b16 v[222:223], v9 offset:16320
    v_mfma_f32_16x16x32_bf16 v[68:71], v[160:163], v[136:139], v[68:71]
    v_add_u32 v9, s54, v9
    v_mfma_f32_16x16x32_bf16 v[68:71], v[164:167], v[140:143], v[68:71]
    s_cmp_lt_u32 s55, 2
    s_cbranch_scc1 C_nw
    s_waitcnt vmcnt(0)
C_nw:
    v_mfma_f32_16x16x32_bf16 v[64:67], v[160:163], v[128:131], v[64:67]
    v_mfma_f32_16x16x32_bf16 v[64:67], v[164:167], v[132:135], v[64:67]
    s_waitcnt lgkmcnt(0)
    s_barrier
    v_mfma_f32_16x16x32_bf16 v[80:83], v[200:203], v[128:131], v[80:83]
    ds_read_b128 v[168:171], v10 offset:0
    v_mfma_f32_16x16x32_bf16 v[80:83], v[204:207], v[132:135], v[80:83]
    ds_read_b128 v[172:175], v11 offset:0
    v_mfma_f32_16x16x32_bf16 v[84:87], v[200:203], v[136:139], v[84:87]
    ds_read_b128 v[176:179], v10 offset:2048
    v_mfma_f32_16x16x32_bf16 v[84:87], v[204:207], v[140:143], v[84:87]
    ds_read_b128 v[180:183], v11 offset:2048
    v_mfma_f32_16x16x32_bf16 v[88:91], v[200:203], v[144:147], v[88:91]
    ds_read_b64_tr_b16 v[160:161], v13 offset:96
    v_mfma_f32_16x16x32_bf16 v[88:91], v[204:207], v[148:151], v[88:91]
    ds_read_b64_tr_b16 v[162:163], v13 offset:1888
    v_mfma_f32_16x16x32_bf16 v[92:95], v[200:203], v[152:155], v[92:95]
    ds_read_b64_tr_b16 v[164:165], v13 offset:14432
    v_mfma_f32_16x16x32_bf16 v[92:95], v[204:207], v[156:159], v[92:95]
    ds_read_b64_tr_b16 v[166:167], v13 offset:16224
    v_mfma_f32_16x16x32_bf16 v[108:111], v[208:211], v[152:155], v[108:111]
    ds_read_b64_tr_b16 v[200:201], v12 offset:0
    v_mfma_f32_16x16x32_bf16 v[108:111], v[212:215], v[156:159], v[108:111]
    ds_read_b64_tr_b16 v[202:203], v12 offset:1792
    v_mfma_f32_16x16x32_bf16 v[104:107], v[208:211], v[144:147], v[104:107]
    ds_read_b64_tr_b16 v[204:205], v12 offset:14336
    v_mfma_f32_16x16x32_bf16 v[104:107], v[212:215], v[148:151], v[104:107]
    ds_read_b64_tr_b16 v[206:207], v12 offset:16128
    v_mfma_f32_16x16x32_bf16 v[100:103], v[208:211], v[136:139], v[100:103]
    ds_read_b128 v[184:187], v10 offset:4096
    v_mfma_f32_16x16x32_bf16 v[100:103], v[212:215], v[140:143], v[100:103]
    ds_read_b128 v[188:191], v11 offset:4096
    v_mfma_f32_16x16x32_bf16 v[96:99], v[208:211], v[128:131], v[96:99]
    ds_read_b128 v[192:195], v10 offset:6144
    v_mfma_f32_16x16x32_bf16 v[96:99], v[212:215], v[132:135], v[96:99]
    ds_read_b128 v[196:199], v11 offset:6144
    v_mfma_f32_16x16x32_bf16 v[112:115], v[216:219], v[128:131], v[112:115]
    ds_read_b64_tr_b16 v[208:209], v13 offset:32
    v_mfma_f32_16x16x32_bf16 v[112:115], v[220:223], v[132:135], v[112:115]
    ds_read_b64_tr_b16 v[210:211], v13 offset:1824
    v_mfma_f32_16x16x32_bf16 v[116:119], v[216:219], v[136:139], v[116:119]
    ds_read_b64_tr_b16 v[212:213], v13 offset:14368
    v_mfma_f32_16x16x32_bf16 v[116:119], v[220:223], v[140:143], v[116:119]
    ds_read_b64_tr_b16 v[214:215], v13 offset:16160
    v_mfma_f32_16x16x32_bf16 v[120:123], v[216:219], v[144:147], v[120:123]
    v_mfma_f32_16x16x32_bf16 v[120:123], v[220:223], v[148:151], v[120:123]
    v_mfma_f32_16x16x32_bf16 v[124:127], v[216:219], v[152:155], v[124:127]
    v_mfma_f32_16x16x32_bf16 v[124:127], v[220:223], v[156:159], v[124:127]
    s_waitcnt lgkmcnt(10)
    v_mfma_f32_16x16x32_bf16 v[16:19], v[200:203], v[168:171], v[16:19]
    ds_read_b64_tr_b16 v[216:217], v12 offset:64
    s_waitcnt lgkmcnt(9)
    v_mfma_f32_16x16x32_bf16 v[16:19], v[204:207], v[172:175], v[16:19]
    ds_read_b64_tr_b16 v[218:219], v12 offset:1856
    v_mfma_f32_16x16x32_bf16 v[20:23], v[200:203], v[176:179], v[20:23]
    ds_read_b64_tr_b16 v[220:221], v12 offset:14400
    v_mfma_f32_16x16x32_bf16 v[20:23], v[204:207], v[180:183], v[20:23]
    ds_read_b64_tr_b16 v[222:223], v12 offset:16192
    s_waitcnt lgkmcnt(11)
    v_mfma_f32_16x16x32_bf16 v[24:27], v[200:203], v[184:187], v[24:27]
    s_waitcnt lgkmcnt(10)
    v_mfma_f32_16x16x32_bf16 v[24:27], v[204:207], v[188:191], v[24:27]
    s_waitcnt lgkmcnt(9)
    v_mfma_f32_16x16x32_bf16 v[28:31], v[200:203], v[192:195], v[28:31]
    s_waitcnt lgkmcnt(8)
    v_mfma_f32_16x16x32_bf16 v[28:31], v[204:207], v[196:199], v[28:31]
    s_waitcnt lgkmcnt(6)
    v_mfma_f32_16x16x32_bf16 v[44:47], v[208:211], v[192:195], v[44:47]
    ds_read_b64_tr_b16 v[200:201], v12 offset:128
    s_waitcnt lgkmcnt(5)
    v_mfma_f32_16x16x32_bf16 v[44:47], v[212:215], v[196:199], v[44:47]
    ds_read_b64_tr_b16 v[202:203], v12 offset:1920
    v_mfma_f32_16x16x32_bf16 v[40:43], v[208:211], v[184:187], v[40:43]
    ds_read_b64_tr_b16 v[204:205], v12 offset:14464
    v_mfma_f32_16x16x32_bf16 v[40:43], v[212:215], v[188:191], v[40:43]
    ds_read_b64_tr_b16 v[206:207], v12 offset:16256
    v_mfma_f32_16x16x32_bf16 v[36:39], v[208:211], v[176:179], v[36:39]
    s_add_u32 s53, s53, 45056
    s_cmp_ge_u32 s53, 135168
    s_cselect_b32 s54, -90112, s52
    v_mfma_f32_16x16x32_bf16 v[36:39], v[212:215], v[180:183], v[36:39]
    s_cselect_b32 s53, 0, s53
    v_add_u32 v10, s54, v10
    v_mfma_f32_16x16x32_bf16 v[32:35], v[208:211], v[168:171], v[32:35]
    v_add_u32 v11, s54, v11
    v_mfma_f32_16x16x32_bf16 v[32:35], v[212:215], v[172:175], v[32:35]
    s_waitcnt lgkmcnt(6)
    v_mfma_f32_16x16x32_bf16 v[48:51], v[216:219], v[168:171], v[48:51]
    ds_read_b64_tr_b16 v[208:209], v13 offset:160
    s_waitcnt lgkmcnt(5)
    v_mfma_f32_16x16x32_bf16 v[48:51], v[220:223], v[172:175], v[48:51]
    ds_read_b64_tr_b16 v[210:211], v13 offset:1952
    v_mfma_f32_16x16x32_bf16 v[52:55], v[216:219], v[176:179], v[52:55]
    ds_read_b64_tr_b16 v[212:213], v13 offset:14496
    v_mfma_f32_16x16x32_bf16 v[52:55], v[220:223], v[180:183], v[52:55]
    ds_read_b64_tr_b16 v[214:215], v13 offset:16288
    v_mfma_f32_16x16x32_bf16 v[56:59], v[216:219], v[184:187], v[56:59]
    v_mfma_f32_16x16x32_bf16 v[56:59], v[220:223], v[188:191], v[56:59]
    v_add_u32 v12, s54, v12
    v_mfma_f32_16x16x32_bf16 v[60:63], v[216:219], v[192:195], v[60:63]
    v_add_u32 v13, s54, v13
    v_mfma_f32_16x16x32_bf16 v[60:63], v[220:223], v[196:199], v[60:63]
    v_mfma_f32_16x16x32_bf16 v[76:79], v[160:163], v[192:195], v[76:79]
    ds_read_b64_tr_b16 v[216:217], v9 offset:192
    v_mfma_f32_16x16x32_bf16 v[76:79], v[164:167], v[196:199], v[76:79]
    ds_read_b64_tr_b16 v[218:219], v9 offset:1984
    v_mfma_f32_16x16x32_bf16 v[72:75], v[160:163], v[184:187], v[72:75]
    ds_read_b64_tr_b16 v[220:221], v9 offset:14528
    v_mfma_f32_16x16x32_bf16 v[72:75], v[164:167], v[188:191], v[72:75]
    ds_read_b64_tr_b16 v[222:223], v9 offset:16320
    v_mfma_f32_16x16x32_bf16 v[68:71], v[160:163], v[176:179], v[68:71]
    v_add_u32 v9, s54, v9
    v_mfma_f32_16x16x32_bf16 v[68:71], v[164:167], v[180:183], v[68:71]
    s_add_u32 s55, s55, 1
    s_cmp_eq_u32 s55, 8
    v_mfma_f32_16x16x32_bf16 v[64:67], v[160:163], v[168:171], v[64:67]
    v_mfma_f32_16x16x32_bf16 v[64:67], v[164:167], v[172:175], v[64:67]
    s_waitcnt lgkmcnt(0)
    s_barrier
    s_cbranch_scc1 C_x1
    v_mfma_f32_16x16x32_bf16 v[80:83], v[200:203], v[168:171], v[80:83]
    ds_read_b128 v[128:131], v10 offset:0
    v_mfma_f32_16x16x32_bf16 v[80:83], v[204:207], v[172:175], v[80:83]
    ds_read_b128 v[132:135], v11 offset:0
    v_mfma_f32_16x16x32_bf16 v[84:87], v[200:203], v[176:179], v[84:87]
    ds_read_b128 v[136:139], v10 offset:2048
    v_mfma_f32_16x16x32_bf16 v[84:87], v[204:207], v[180:183], v[84:87]
    ds_read_b128 v[140:143], v11 offset:2048
    v_mfma_f32_16x16x32_bf16 v[88:91], v[200:203], v[184:187], v[88:91]
    ds_read_b64_tr_b16 v[160:161], v13 offset:96
    v_mfma_f32_16x16x32_bf16 v[88:91], v[204:207], v[188:191], v[88:91]
    ds_read_b64_tr_b16 v[162:163], v13 offset:1888
    v_mfma_f32_16x16x32_bf16 v[92:95], v[200:203], v[192:195], v[92:95]
    ds_read_b64_tr_b16 v[164:165], v13 offset:14432
    v_mfma_f32_16x16x32_bf16 v[92:95], v[204:207], v[196:199], v[92:95]
    ds_read_b64_tr_b16 v[166:167], v13 offset:16224
    v_mfma_f32_16x16x32_bf16 v[108:111], v[208:211], v[192:195], v[108:111]
    ds_read_b64_tr_b16 v[200:201], v12 offset:0
    v_mfma_f32_16x16x32_bf16 v[108:111], v[212:215], v[196:199], v[108:111]
    ds_read_b64_tr_b16 v[202:203], v12 offset:1792
    v_mfma_f32_16x16x32_bf16 v[104:107], v[208:211], v[184:187], v[104:107]
    ds_read_b64_tr_b16 v[204:205], v12 offset:14336
    v_mfma_f32_16x16x32_bf16 v[104:107], v[212:215], v[188:191], v[104:107]
    ds_read_b64_tr_b16 v[206:207], v12 offset:16128
    v_mfma_f32_16x16x32_bf16 v[100:103], v[208:211], v[176:179], v[100:103]
    ds_read_b128 v[144:147], v10 offset:4096
    v_mfma_f32_16x16x32_bf16 v[100:103], v[212:215], v[180:183], v[100:103]
    ds_read_b128 v[148:151], v11 offset:4096
    v_mfma_f32_16x16x32_bf16 v[96:99], v[208:211], v[168:171], v[96:99]
    ds_read_b128 v[152:155], v10 offset:6144
    v_mfma_f32_16x16x32_bf16 v[96:99], v[212:215], v[172:175], v[96:99]
    ds_read_b128 v[156:159], v11 offset:6144
    v_mfma_f32_16x16x32_bf16 v[112:115], v[216:219], v[168:171], v[112:115]
    ds_read_b64_tr_b16 v[208:209], v13 offset:32
    v_mfma_f32_16x16x32_bf16 v[112:115], v[220:223], v[172:175], v[112:115]
    ds_read_b64_tr_b16 v[210:211], v13 offset:1824
    v_mfma_f32_16x16x32_bf16 v[116:119], v[216:219], v[176:179], v[116:119]
    ds_read_b64_tr_b16 v[212:213], v13 offset:14368
    v_mfma_f32_16x16x32_bf16 v[116:119], v[220:223], v[180:183], v[116:119]
    ds_read_b64_tr_b16 v[214:215], v13 offset:16160
    v_mfma_f32_16x16x32_bf16 v[120:123], v[216:219], v[184:187], v[120:123]
    v_mfma_f32_16x16x32_bf16 v[120:123], v[220:223], v[188:191], v[120:123]
    v_mfma_f32_16x16x32_bf16 v[124:127], v[216:219], v[192:195], v[124:127]
    v_mfma_f32_16x16x32_bf16 v[124:127], v[220:223], v[196:199], v[124:127]
    s_branch C_l1
C_x1:
    v_mfma_f32_16x16x32_bf16 v[80:83], v[200:203], v[168:171], v[80:83]
    ds_read_b64 v[156:157], v247 offset:0
    v_mfma_f32_16x16x32_bf16 v[80:83], v[204:207], v[172:175], v[80:83]
    ds_read_b64 v[158:159], v247 offset:128
    v_mfma_f32_16x16x32_bf16 v[84:87], v[200:203], v[176:179], v[84:87]
    ds_read_b64 v[160:161], v247 offset:256
    v_mfma_f32_16x16x32_bf16 v[84:87], v[204:207], v[180:183], v[84:87]
    ds_read_b64 v[162:163], v247 offset:384
    v_mfma_f32_16x16x32_bf16 v[88:91], v[200:203], v[184:187], v[88:91]
    v_mov_b32 v15, 162812
    ds_read_b32 v15, v15
    v_mfma_f32_16x16x32_bf16 v[88:91], v[204:207], v[188:191], v[88:91]
    ds_read_b128 v[128:131], v246 offset:0
    v_mfma_f32_16x16x32_bf16 v[92:95], v[200:203], v[192:195], v[92:95]
    ds_read_b128 v[132:135], v246 offset:64
    v_mfma_f32_16x16x32_bf16 v[92:95], v[204:207], v[196:199], v[92:95]
    ds_read_b128 v[136:139], v246 offset:128
    v_mfma_f32_16x16x32_bf16 v[108:111], v[208:211], v[192:195], v[108:111]
    ds_read_b128 v[140:143], v246 offset:192
    v_mfma_f32_16x16x32_bf16 v[108:111], v[212:215], v[196:199], v[108:111]
    ds_read_b128 v[144:147], v246 offset:256
    v_mfma_f32_16x16x32_bf16 v[104:107], v[208:211], v[184:187], v[104:107]
    ds_read_b128 v[148:151], v246 offset:320
    v_mfma_f32_16x16x32_bf16 v[104:107], v[212:215], v[188:191], v[104:107]
    ds_read_b128 v[152:155], v245 offset:384
    v_mfma_f32_16x16x32_bf16 v[100:103], v[208:211], v[176:179], v[100:103]
    v_mfma_f32_16x16x32_bf16 v[100:103], v[212:215], v[180:183], v[100:103]
    v_mfma_f32_16x16x32_bf16 v[96:99], v[208:211], v[168:171], v[96:99]
    s_waitcnt lgkmcnt(0)
    v_mfma_f32_16x16x32_bf16 v[96:99], v[212:215], v[172:175], v[96:99]
    v_rcp_f32 v224, v157
    v_sub_f32 v228, 0, v156
    v_mfma_f32_16x16x32_bf16 v[112:115], v[216:219], v[168:171], v[112:115]
    v_rcp_f32 v225, v159
    v_sub_f32 v230, 0, v158
    v_mfma_f32_16x16x32_bf16 v[112:115], v[220:223], v[172:175], v[112:115]
    v_rcp_f32 v226, v161
    v_sub_f32 v232, 0, v160
    v_mfma_f32_16x16x32_bf16 v[116:119], v[216:219], v[176:179], v[116:119]
    v_rcp_f32 v227, v163
    v_sub_f32 v234, 0, v162
    v_mfma_f32_16x16x32_bf16 v[116:119], v[220:223], v[180:183], v[116:119]
    v_mfma_f32_16x16x32_bf16 v[120:123], v[216:219], v[184:187], v[120:123]
    v_mul_f32 v229, 0xbfb8aa3b, v224
    v_mfma_f32_16x16x32_bf16 v[120:123], v[220:223], v[188:191], v[120:123]
    v_mul_f32 v231, 0xbfb8aa3b, v225
    v_mfma_f32_16x16x32_bf16 v[124:127], v[216:219], v[192:195], v[124:127]
    v_mul_f32 v233, 0xbfb8aa3b, v226
    v_mfma_f32_16x16x32_bf16 v[124:127], v[220:223], v[196:199], v[124:127]
    v_mul_f32 v235, 0xbfb8aa3b, v227
    s_add_u32 s52, s62, 32112640
C_w0:
    v_fmac_f32 v16, v228, v128
    v_fmac_f32 v17, v228, v129
    v_fmac_f32 v18, v228, v130
    v_fmac_f32 v19, v228, v131
    v_fmac_f32 v32, v228, v132
    v_fmac_f32 v33, v228, v133
    v_fmac_f32 v34, v228, v134
    v_fmac_f32 v35, v228, v135
    v_mul_f32 v208, v229, v16
    v_mul_f32 v209, v229, v17
    v_mul_f32 v210, v229, v18
    v_mul_f32 v211, v229, v19
    v_mul_f32 v212, v229, v32
    v_mul_f32 v213, v229, v33
    v_mul_f32 v214, v229, v34
    v_mul_f32 v215, v229, v35
    v_exp_f32 v208, v208
    v_exp_f32 v209, v209
    v_exp_f32 v210, v210
    v_exp_f32 v211, v211
    v_exp_f32 v212, v212
    v_exp_f32 v213, v213
    v_exp_f32 v214, v214
    v_exp_f32 v215, v215
    v_fma_f32 v208, v208, v157, v157
    v_fma_f32 v209, v209, v157, v157
    v_fma_f32 v210, v210, v157, v157
    v_fma_f32 v211, v211, v157, v157
    v_fma_f32 v212, v212, v157, v157
    v_fma_f32 v213, v213, v157, v157
    v_fma_f32 v214, v214, v157, v157
    v_fma_f32 v215, v215, v157, v157
    v_rcp_f32 v208, v208
    v_rcp_f32 v209, v209
    v_rcp_f32 v210, v210
    v_rcp_f32 v211, v211
    v_rcp_f32 v212, v212
    v_rcp_f32 v213, v213
    v_rcp_f32 v214, v214
    v_rcp_f32 v215, v215
    v_mul_f32 v16, v16, v208
    v_mul_f32 v17, v17, v209
    v_mul_f32 v18, v18, v210
    v_mul_f32 v19, v19, v211
    v_mul_f32 v32, v32, v212
    v_mul_f32 v33, v33, v213
    v_mul_f32 v34, v34, v214
    v_mul_f32 v35, v35, v215
    v_cvt_pk_bf16_f32 v164, v16, v17
    v_cvt_pk_bf16_f32 v166, v32, v33
    v_cvt_pk_bf16_f32 v165, v18, v19
    v_cvt_pk_bf16_f32 v167, v34, v35
    s_add_u32 s53, s0, 0
    v_permlane16_swap_b32 v164, v166
    v_permlane16_swap_b32 v165, v167
    buffer_store_dwordx4 v[164:167], v248, s[40:43], s53 offen sc1
    ds_write_b128 v243, v[164:167] offset:0
WS18:
    v_fmac_f32 v20, v230, v128
    v_fmac_f32 v21, v230, v129
    v_fmac_f32 v22, v230, v130
    v_fmac_f32 v23, v230, v131
    v_fmac_f32 v36, v230, v132
    v_fmac_f32 v37, v230, v133
    v_fmac_f32 v38, v230, v134
    v_fmac_f32 v39, v230, v135
    v_mul_f32 v208, v231, v20
    v_mul_f32 v209, v231, v21
    v_mul_f32 v210, v231, v22
    v_mul_f32 v211, v231, v23
    v_mul_f32 v212, v231, v36
    v_mul_f32 v213, v231, v37
    v_mul_f32 v214, v231, v38
    v_mul_f32 v215, v231, v39
    v_exp_f32 v208, v208
    v_exp_f32 v209, v209
    v_exp_f32 v210, v210
    v_exp_f32 v211, v211
    v_exp_f32 v212, v212
    v_exp_f32 v213, v213
    v_exp_f32 v214, v214
    v_exp_f32 v215, v215
    v_fma_f32 v208, v208, v159, v159
    v_fma_f32 v209, v209, v159, v159
    v_fma_f32 v210, v210, v159, v159
    v_fma_f32 v211, v211, v159, v159
    v_fma_f32 v212, v212, v159, v159
    v_fma_f32 v213, v213, v159, v159
    v_fma_f32 v214, v214, v159, v159
    v_fma_f32 v215, v215, v159, v159
    v_rcp_f32 v208, v208
    v_rcp_f32 v209, v209
    v_rcp_f32 v210, v210
    v_rcp_f32 v211, v211
    v_rcp_f32 v212, v212
    v_rcp_f32 v213, v213
    v_rcp_f32 v214, v214
    v_rcp_f32 v215, v215
    v_mul_f32 v20, v20, v208
    v_mul_f32 v21, v21, v209
    v_mul_f32 v22, v22, v210
    v_mul_f32 v23, v23, v211
    v_mul_f32 v36, v36, v212
    v_mul_f32 v37, v37, v213
    v_mul_f32 v38, v38, v214
    v_mul_f32 v39, v39, v215
    v_cvt_pk_bf16_f32 v168, v20, v21
    v_cvt_pk_bf16_f32 v170, v36, v37
    v_cvt_pk_bf16_f32 v169, v22, v23
    v_cvt_pk_bf16_f32 v171, v38, v39
    s_add_u32 s53, s0, 114688
    v_permlane16_swap_b32 v168, v170
    v_permlane16_swap_b32 v169, v171
    buffer_store_dwordx4 v[168:171], v248, s[40:43], s53 offen sc1
    ds_write_b128 v243, v[168:171] offset:2048
WS19:
    v_fmac_f32 v24, v232, v128
    v_fmac_f32 v25, v232, v129
    v_fmac_f32 v26, v232, v130
    v_fmac_f32 v27, v232, v131
    v_fmac_f32 v40, v232, v132
    v_fmac_f32 v41, v232, v133
    v_fmac_f32 v42, v232, v134
    v_fmac_f32 v43, v232, v135
    v_mul_f32 v208, v233, v24
    v_mul_f32 v209, v233, v25
    v_mul_f32 v210, v233, v26
    v_mul_f32 v211, v233, v27
    v_mul_f32 v212, v233, v40
    v_mul_f32 v213, v233, v41
    v_mul_f32 v214, v233, v42
    v_mul_f32 v215, v233, v43
    v_exp_f32 v208, v208
    v_exp_f32 v209, v209
    v_exp_f32 v210, v210
    v_exp_f32 v211, v211
    v_exp_f32 v212, v212
    v_exp_f32 v213, v213
    v_exp_f32 v214, v214
    v_exp_f32 v215, v215
    v_fma_f32 v208, v208, v161, v161
    v_fma_f32 v209, v209, v161, v161
    v_fma_f32 v210, v210, v161, v161
    v_fma_f32 v211, v211, v161, v161
    v_fma_f32 v212, v212, v161, v161
    v_fma_f32 v213, v213, v161, v161
    v_fma_f32 v214, v214, v161, v161
    v_fma_f32 v215, v215, v161, v161
    v_rcp_f32 v208, v208
    v_rcp_f32 v209, v209
    v_rcp_f32 v210, v210
    v_rcp_f32 v211, v211
    v_rcp_f32 v212, v212
    v_rcp_f32 v213, v213
    v_rcp_f32 v214, v214
    v_rcp_f32 v215, v215
    v_mul_f32 v24, v24, v208
    v_mul_f32 v25, v25, v209
    v_mul_f32 v26, v26, v210
    v_mul_f32 v27, v27, v211
    v_mul_f32 v40, v40, v212
    v_mul_f32 v41, v41, v213
    v_mul_f32 v42, v42, v214
    v_mul_f32 v43, v43, v215
    v_cvt_pk_bf16_f32 v172, v24, v25
    v_cvt_pk_bf16_f32 v174, v40, v41
    v_cvt_pk_bf16_f32 v173, v26, v27
    v_cvt_pk_bf16_f32 v175, v42, v43
    s_add_u32 s53, s0, 229376
    v_permlane16_swap_b32 v172, v174
    v_permlane16_swap_b32 v173, v175
    buffer_store_dwordx4 v[172:175], v248, s[40:43], s53 offen sc1
    ds_write_b128 v243, v[172:175] offset:4096
WS20:
    v_fmac_f32 v28, v234, v128
    v_fmac_f32 v29, v234, v129
    v_fmac_f32 v30, v234, v130
    v_fmac_f32 v31, v234, v131
    v_fmac_f32 v44, v234, v132
    v_fmac_f32 v45, v234, v133
    v_fmac_f32 v46, v234, v134
    v_fmac_f32 v47, v234, v135
    v_mul_f32 v208, v235, v28
    v_mul_f32 v209, v235, v29
    v_mul_f32 v210, v235, v30
    v_mul_f32 v211, v235, v31
    v_mul_f32 v212, v235, v44
    v_mul_f32 v213, v235, v45
    v_mul_f32 v214, v235, v46
    v_mul_f32 v215, v235, v47
    v_exp_f32 v208, v208
    v_exp_f32 v209, v209
    v_exp_f32 v210, v210
    v_exp_f32 v211, v211
    v_exp_f32 v212, v212
    v_exp_f32 v213, v213
    v_exp_f32 v214, v214
    v_exp_f32 v215, v215
    v_fma_f32 v208, v208, v163, v163
    v_fma_f32 v209, v209, v163, v163
    v_fma_f32 v210, v210, v163, v163
    v_fma_f32 v211, v211, v163, v163
    v_fma_f32 v212, v212, v163, v163
    v_fma_f32 v213, v213, v163, v163
    v_fma_f32 v214, v214, v163, v163
    v_fma_f32 v215, v215, v163, v163
    v_rcp_f32 v208, v208
    v_rcp_f32 v209, v209
    v_rcp_f32 v210, v210
    v_rcp_f32 v211, v211
    v_rcp_f32 v212, v212
    v_rcp_f32 v213, v213
    v_rcp_f32 v214, v214
    v_rcp_f32 v215, v215
    v_mul_f32 v28, v28, v208
    v_mul_f32 v29, v29, v209
    v_mul_f32 v30, v30, v210
    v_mul_f32 v31, v31, v211
    v_mul_f32 v44, v44, v212
    v_mul_f32 v45, v45, v213
    v_mul_f32 v46, v46, v214
    v_mul_f32 v47, v47, v215
    v_cvt_pk_bf16_f32 v164, v28, v29
    v_cvt_pk_bf16_f32 v166, v44, v45
    v_cvt_pk_bf16_f32 v165, v30, v31
    v_cvt_pk_bf16_f32 v167, v46, v47
    s_add_u32 s53, s0, 344064
    v_permlane16_swap_b32 v164, v166
    v_permlane16_swap_b32 v165, v167
    buffer_store_dwordx4 v[164:167], v248, s[40:43], s53 offen sc1
    ds_write_b128 v243, v[164:167] offset:6144
WS21:
    v_fmac_f32 v48, v228, v136
    v_fmac_f32 v49, v228, v137
    v_fmac_f32 v50, v228, v138
    v_fmac_f32 v51, v228, v139
    v_fmac_f32 v64, v228, v140
    v_fmac_f32 v65, v228, v141
    v_fmac_f32 v66, v228, v142
    v_fmac_f32 v67, v228, v143
    v_mul_f32 v208, v229, v48
    v_mul_f32 v209, v229, v49
    v_mul_f32 v210, v229, v50
    v_mul_f32 v211, v229, v51
    v_mul_f32 v212, v229, v64
    v_mul_f32 v213, v229, v65
    v_mul_f32 v214, v229, v66
    v_mul_f32 v215, v229, v67
    v_exp_f32 v208, v208
    v_exp_f32 v209, v209
    v_exp_f32 v210, v210
    v_exp_f32 v211, v211
    v_exp_f32 v212, v212
    v_exp_f32 v213, v213
    v_exp_f32 v214, v214
    v_exp_f32 v215, v215
    v_fma_f32 v208, v208, v157, v157
    v_fma_f32 v209, v209, v157, v157
    v_fma_f32 v210, v210, v157, v157
    v_fma_f32 v211, v211, v157, v157
    v_fma_f32 v212, v212, v157, v157
    v_fma_f32 v213, v213, v157, v157
    v_fma_f32 v214, v214, v157, v157
    v_fma_f32 v215, v215, v157, v157
    v_rcp_f32 v208, v208
    v_rcp_f32 v209, v209
    v_rcp_f32 v210, v210
    v_rcp_f32 v211, v211
    v_rcp_f32 v212, v212
    v_rcp_f32 v213, v213
    v_rcp_f32 v214, v214
    v_rcp_f32 v215, v215
    v_mul_f32 v48, v48, v208
    v_mul_f32 v49, v49, v209
    v_mul_f32 v50, v50, v210
    v_mul_f32 v51, v51, v211
    v_mul_f32 v64, v64, v212
    v_mul_f32 v65, v65, v213
    v_mul_f32 v66, v66, v214
    v_mul_f32 v67, v67, v215
    v_cvt_pk_bf16_f32 v168, v48, v49
    v_cvt_pk_bf16_f32 v170, v64, v65
    v_cvt_pk_bf16_f32 v169, v50, v51
    v_cvt_pk_bf16_f32 v171, v66, v67
    s_add_u32 s53, s0, 32768
    v_permlane16_swap_b32 v168, v170
    v_permlane16_swap_b32 v169, v171
    buffer_store_dwordx4 v[168:171], v248, s[40:43], s53 offen sc1
    ds_write_b128 v243, v[168:171] offset:49152
WS22:
    v_fmac_f32 v52, v230, v136
    v_fmac_f32 v53, v230, v137
    v_fmac_f32 v54, v230, v138
    v_fmac_f32 v55, v230, v139
    v_fmac_f32 v68, v230, v140
    v_fmac_f32 v69, v230, v141
    v_fmac_f32 v70, v230, v142
    v_fmac_f32 v71, v230, v143
    v_mul_f32 v208, v231, v52
    v_mul_f32 v209, v231, v53
    v_mul_f32 v210, v231, v54
    v_mul_f32 v211, v231, v55
    v_mul_f32 v212, v231, v68
    v_mul_f32 v213, v231, v69
    v_mul_f32 v214, v231, v70
    v_mul_f32 v215, v231, v71
    v_exp_f32 v208, v208
    v_exp_f32 v209, v209
    v_exp_f32 v210, v210
    v_exp_f32 v211, v211
    v_exp_f32 v212, v212
    v_exp_f32 v213, v213
    v_exp_f32 v214, v214
    v_exp_f32 v215, v215
    v_fma_f32 v208, v208, v159, v159
    v_fma_f32 v209, v209, v159, v159
    v_fma_f32 v210, v210, v159, v159
    v_fma_f32 v211, v211, v159, v159
    v_fma_f32 v212, v212, v159, v159
    v_fma_f32 v213, v213, v159, v159
    v_fma_f32 v214, v214, v159, v159
    v_fma_f32 v215, v215, v159, v159
    v_rcp_f32 v208, v208
    v_rcp_f32 v209, v209
    v_rcp_f32 v210, v210
    v_rcp_f32 v211, v211
    v_rcp_f32 v212, v212
    v_rcp_f32 v213, v213
    v_rcp_f32 v214, v214
    v_rcp_f32 v215, v215
    v_mul_f32 v52, v52, v208
    v_mul_f32 v53, v53, v209
    v_mul_f32 v54, v54, v210
    v_mul_f32 v55, v55, v211
    v_mul_f32 v68, v68, v212
    v_mul_f32 v69, v69, v213
    v_mul_f32 v70, v70, v214
    v_mul_f32 v71, v71, v215
    v_cvt_pk_bf16_f32 v172, v52, v53
    v_cvt_pk_bf16_f32 v174, v68, v69
    v_cvt_pk_bf16_f32 v173, v54, v55
    v_cvt_pk_bf16_f32 v175, v70, v71
    s_add_u32 s53, s0, 147456
    v_permlane16_swap_b32 v172, v174
    v_permlane16_swap_b32 v173, v175
    buffer_store_dwordx4 v[172:175], v248, s[40:43], s53 offen sc1
    ds_write_b128 v243, v[172:175] offset:51200
WS23:
    v_fmac_f32 v56, v232, v136
    v_fmac_f32 v57, v232, v137
    v_fmac_f32 v58, v232, v138
    v_fmac_f32 v59, v232, v139
    v_fmac_f32 v72, v232, v140
    v_fmac_f32 v73, v232, v141
    v_fmac_f32 v74, v232, v142
    v_fmac_f32 v75, v232, v143
    v_mul_f32 v208, v233, v56
    v_mul_f32 v209, v233, v57
    v_mul_f32 v210, v233, v58
    v_mul_f32 v211, v233, v59
    v_mul_f32 v212, v233, v72
    v_mul_f32 v213, v233, v73
    v_mul_f32 v214, v233, v74
    v_mul_f32 v215, v233, v75
    v_exp_f32 v208, v208
    v_exp_f32 v209, v209
    v_exp_f32 v210, v210
    v_exp_f32 v211, v211
    v_exp_f32 v212, v212
    v_exp_f32 v213, v213
    v_exp_f32 v214, v214
    v_exp_f32 v215, v215
    v_fma_f32 v208, v208, v161, v161
    v_fma_f32 v209, v209, v161, v161
    v_fma_f32 v210, v210, v161, v161
    v_fma_f32 v211, v211, v161, v161
    v_fma_f32 v212, v212, v161, v161
    v_fma_f32 v213, v213, v161, v161
    v_fma_f32 v214, v214, v161, v161
    v_fma_f32 v215, v215, v161, v161
    v_rcp_f32 v208, v208
    v_rcp_f32 v209, v209
    v_rcp_f32 v210, v210
    v_rcp_f32 v211, v211
    v_rcp_f32 v212, v212
    v_rcp_f32 v213, v213
    v_rcp_f32 v214, v214
    v_rcp_f32 v215, v215
    v_mul_f32 v56, v56, v208
    v_mul_f32 v57, v57, v209
    v_mul_f32 v58, v58, v210
    v_mul_f32 v59, v59, v211
    v_mul_f32 v72, v72, v212
    v_mul_f32 v73, v73, v213
    v_mul_f32 v74, v74, v214
    v_mul_f32 v75, v75, v215
    v_cvt_pk_bf16_f32 v164, v56, v57
    v_cvt_pk_bf16_f32 v166, v72, v73
    v_cvt_pk_bf16_f32 v165, v58, v59
    v_cvt_pk_bf16_f32 v167, v74, v75
    s_add_u32 s53, s0, 262144
    v_permlane16_swap_b32 v164, v166
    v_permlane16_swap_b32 v165, v167
    buffer_store_dwordx4 v[164:167], v248, s[40:43], s53 offen sc1
    ds_write_b128 v243, v[164:167] offset:53248
    s_waitcnt vmcnt(3)
    s_mov_b32 exec_hi, 0
    buffer_store_dword v15, v5, s[40:43], s52 offen offset:0 sc1
    s_mov_b64 exec, -1
    s_add_u32 s52, s52, 131072
WS24:
    v_fmac_f32 v60, v234, v136
    v_fmac_f32 v61, v234, v137
    v_fmac_f32 v62, v234, v138
    v_fmac_f32 v63, v234, v139
    v_fmac_f32 v76, v234, v140
    v_fmac_f32 v77, v234, v141
    v_fmac_f32 v78, v234, v142
    v_fmac_f32 v79, v234, v143
    v_mul_f32 v208, v235, v60
    v_mul_f32 v209, v235, v61
    v_mul_f32 v210, v235, v62
    v_mul_f32 v211, v235, v63
    v_mul_f32 v212, v235, v76
    v_mul_f32 v213, v235, v77
    v_mul_f32 v214, v235, v78
    v_mul_f32 v215, v235, v79
    v_exp_f32 v208, v208
    v_exp_f32 v209, v209
    v_exp_f32 v210, v210
    v_exp_f32 v211, v211
    v_exp_f32 v212, v212
    v_exp_f32 v213, v213
    v_exp_f32 v214, v214
    v_exp_f32 v215, v215
    v_fma_f32 v208, v208, v163, v163
    v_fma_f32 v209, v209, v163, v163
    v_fma_f32 v210, v210, v163, v163
    v_fma_f32 v211, v211, v163, v163
    v_fma_f32 v212, v212, v163, v163
    v_fma_f32 v213, v213, v163, v163
    v_fma_f32 v214, v214, v163, v163
    v_fma_f32 v215, v215, v163, v163
    v_rcp_f32 v208, v208
    v_rcp_f32 v209, v209
    v_rcp_f32 v210, v210
    v_rcp_f32 v211, v211
    v_rcp_f32 v212, v212
    v_rcp_f32 v213, v213
    v_rcp_f32 v214, v214
    v_rcp_f32 v215, v215
    v_mul_f32 v60, v60, v208
    v_mul_f32 v61, v61, v209
    v_mul_f32 v62, v62, v210
    v_mul_f32 v63, v63, v211
    v_mul_f32 v76, v76, v212
    v_mul_f32 v77, v77, v213
    v_mul_f32 v78, v78, v214
    v_mul_f32 v79, v79, v215
    v_cvt_pk_bf16_f32 v168, v60, v61
    v_cvt_pk_bf16_f32 v170, v76, v77
    v_cvt_pk_bf16_f32 v169, v62, v63
    v_cvt_pk_bf16_f32 v171, v78, v79
    s_add_u32 s53, s0, 376832
    v_permlane16_swap_b32 v168, v170
    v_permlane16_swap_b32 v169, v171
    buffer_store_dwordx4 v[168:171], v248, s[40:43], s53 offen sc1
    ds_write_b128 v243, v[168:171] offset:55296
WS25:
    v_fmac_f32 v80, v228, v144
    v_fmac_f32 v81, v228, v145
    v_fmac_f32 v82, v228, v146
    v_fmac_f32 v83, v228, v147
    v_fmac_f32 v96, v228, v148
    v_fmac_f32 v97, v228, v149
    v_fmac_f32 v98, v228, v150
    v_fmac_f32 v99, v228, v151
    v_mul_f32 v208, v229, v80
    v_mul_f32 v209, v229, v81
    v_mul_f32 v210, v229, v82
    v_mul_f32 v211, v229, v83
    v_mul_f32 v212, v229, v96
    v_mul_f32 v213, v229, v97
    v_mul_f32 v214, v229, v98
    v_mul_f32 v215, v229, v99
    v_exp_f32 v208, v208
    v_exp_f32 v209, v209
    v_exp_f32 v210, v210
    v_exp_f32 v211, v211
    v_exp_f32 v212, v212
    v_exp_f32 v213, v213
    v_exp_f32 v214, v214
    v_exp_f32 v215, v215
    v_fma_f32 v208, v208, v157, v157
    v_fma_f32 v209, v209, v157, v157
    v_fma_f32 v210, v210, v157, v157
    v_fma_f32 v211, v211, v157, v157
    v_fma_f32 v212, v212, v157, v157
    v_fma_f32 v213, v213, v157, v157
    v_fma_f32 v214, v214, v157, v157
    v_fma_f32 v215, v215, v157, v157
    v_rcp_f32 v208, v208
    v_rcp_f32 v209, v209
    v_rcp_f32 v210, v210
    v_rcp_f32 v211, v211
    v_rcp_f32 v212, v212
    v_rcp_f32 v213, v213
    v_rcp_f32 v214, v214
    v_rcp_f32 v215, v215
    v_mul_f32 v80, v80, v208
    v_mul_f32 v81, v81, v209
    v_mul_f32 v82, v82, v210
    v_mul_f32 v83, v83, v211
    v_mul_f32 v96, v96, v212
    v_mul_f32 v97, v97, v213
    v_mul_f32 v98, v98, v214
    v_mul_f32 v99, v99, v215
    v_cvt_pk_bf16_f32 v192, v80, v81
    v_cvt_pk_bf16_f32 v194, v96, v97
    v_cvt_pk_bf16_f32 v193, v82, v83
    v_cvt_pk_bf16_f32 v195, v98, v99
    s_add_u32 s53, s0, 65536
    v_permlane16_swap_b32 v192, v194
    v_permlane16_swap_b32 v193, v195
    buffer_store_dwordx4 v[192:195], v248, s[40:43], s53 offen sc1
WS26:
    v_fmac_f32 v84, v230, v144
    v_fmac_f32 v85, v230, v145
    v_fmac_f32 v86, v230, v146
    v_fmac_f32 v87, v230, v147
    v_fmac_f32 v100, v230, v148
    v_fmac_f32 v101, v230, v149
    v_fmac_f32 v102, v230, v150
    v_fmac_f32 v103, v230, v151
    v_mul_f32 v208, v231, v84
    v_mul_f32 v209, v231, v85
    v_mul_f32 v210, v231, v86
    v_mul_f32 v211, v231, v87
    v_mul_f32 v212, v231, v100
    v_mul_f32 v213, v231, v101
    v_mul_f32 v214, v231, v102
    v_mul_f32 v215, v231, v103
    v_exp_f32 v208, v208
    v_exp_f32 v209, v209
    v_exp_f32 v210, v210
    v_exp_f32 v211, v211
    v_exp_f32 v212, v212
    v_exp_f32 v213, v213
    v_exp_f32 v214, v214
    v_exp_f32 v215, v215
    v_fma_f32 v208, v208, v159, v159
    v_fma_f32 v209, v209, v159, v159
    v_fma_f32 v210, v210, v159, v159
    v_fma_f32 v211, v211, v159, v159
    v_fma_f32 v212, v212, v159, v159
    v_fma_f32 v213, v213, v159, v159
    v_fma_f32 v214, v214, v159, v159
    v_fma_f32 v215, v215, v159, v159
    v_rcp_f32 v208, v208
    v_rcp_f32 v209, v209
    v_rcp_f32 v210, v210
    v_rcp_f32 v211, v211
    v_rcp_f32 v212, v212
    v_rcp_f32 v213, v213
    v_rcp_f32 v214, v214
    v_rcp_f32 v215, v215
    v_mul_f32 v84, v84, v208
    v_mul_f32 v85, v85, v209
    v_mul_f32 v86, v86, v210
    v_mul_f32 v87, v87, v211
    v_mul_f32 v100, v100, v212
    v_mul_f32 v101, v101, v213
    v_mul_f32 v102, v102, v214
    v_mul_f32 v103, v103, v215
    v_cvt_pk_bf16_f32 v196, v84, v85
    v_cvt_pk_bf16_f32 v198, v100, v101
    v_cvt_pk_bf16_f32 v197, v86, v87
    v_cvt_pk_bf16_f32 v199, v102, v103
    s_add_u32 s53, s0, 180224
    v_permlane16_swap_b32 v196, v198
    v_permlane16_swap_b32 v197, v199
    buffer_store_dwordx4 v[196:199], v248, s[40:43], s53 offen sc1
WS27:
    v_fmac_f32 v88, v232, v144
    v_fmac_f32 v89, v232, v145
    v_fmac_f32 v90, v232, v146
    v_fmac_f32 v91, v232, v147
    v_fmac_f32 v104, v232, v148
    v_fmac_f32 v105, v232, v149
    v_fmac_f32 v106, v232, v150
    v_fmac_f32 v107, v232, v151
    v_mul_f32 v208, v233, v88
    v_mul_f32 v209, v233, v89
    v_mul_f32 v210, v233, v90
    v_mul_f32 v211, v233, v91
    v_mul_f32 v212, v233, v104
    v_mul_f32 v213, v233, v105
    v_mul_f32 v214, v233, v106
    v_mul_f32 v215, v233, v107
    v_exp_f32 v208, v208
    v_exp_f32 v209, v209
    v_exp_f32 v210, v210
    v_exp_f32 v211, v211
    v_exp_f32 v212, v212
    v_exp_f32 v213, v213
    v_exp_f32 v214, v214
    v_exp_f32 v215, v215
    v_fma_f32 v208, v208, v161, v161
    v_fma_f32 v209, v209, v161, v161
    v_fma_f32 v210, v210, v161, v161
    v_fma_f32 v211, v211, v161, v161
    v_fma_f32 v212, v212, v161, v161
    v_fma_f32 v213, v213, v161, v161
    v_fma_f32 v214, v214, v161, v161
    v_fma_f32 v215, v215, v161, v161
    v_rcp_f32 v208, v208
    v_rcp_f32 v209, v209
    v_rcp_f32 v210, v210
    v_rcp_f32 v211, v211
    v_rcp_f32 v212, v212
    v_rcp_f32 v213, v213
    v_rcp_f32 v214, v214
    v_rcp_f32 v215, v215
    v_mul_f32 v88, v88, v208
    v_mul_f32 v89, v89, v209
    v_mul_f32 v90, v90, v210
    v_mul_f32 v91, v91, v211
    v_mul_f32 v104, v104, v212
    v_mul_f32 v105, v105, v213
    v_mul_f32 v106, v106, v214
    v_mul_f32 v107, v107, v215
    v_cvt_pk_bf16_f32 v200, v88, v89
    v_cvt_pk_bf16_f32 v202, v104, v105
    v_cvt_pk_bf16_f32 v201, v90, v91
    v_cvt_pk_bf16_f32 v203, v106, v107
    s_add_u32 s53, s0, 294912
    v_permlane16_swap_b32 v200, v202
    v_permlane16_swap_b32 v201, v203
    buffer_store_dwordx4 v[200:203], v248, s[40:43], s53 offen sc1
WS28:
    v_fmac_f32 v92, v234, v144
    v_fmac_f32 v93, v234, v145
    v_fmac_f32 v94, v234, v146
    v_fmac_f32 v95, v234, v147
    v_fmac_f32 v108, v234, v148
    v_fmac_f32 v109, v234, v149
    v_fmac_f32 v110, v234, v150
    v_fmac_f32 v111, v234, v151
    v_mul_f32 v208, v235, v92
    v_mul_f32 v209, v235, v93
    v_mul_f32 v210, v235, v94
    v_mul_f32 v211, v235, v95
    v_mul_f32 v212, v235, v108
    v_mul_f32 v213, v235, v109
    v_mul_f32 v214, v235, v110
    v_mul_f32 v215, v235, v111
    v_exp_f32 v208, v208
    v_exp_f32 v209, v209
    v_exp_f32 v210, v210
    v_exp_f32 v211, v211
    v_exp_f32 v212, v212
    v_exp_f32 v213, v213
    v_exp_f32 v214, v214
    v_exp_f32 v215, v215
    v_fma_f32 v208, v208, v163, v163
    v_fma_f32 v209, v209, v163, v163
    v_fma_f32 v210, v210, v163, v163
    v_fma_f32 v211, v211, v163, v163
    v_fma_f32 v212, v212, v163, v163
    v_fma_f32 v213, v213, v163, v163
    v_fma_f32 v214, v214, v163, v163
    v_fma_f32 v215, v215, v163, v163
    v_rcp_f32 v208, v208
    v_rcp_f32 v209, v209
    v_rcp_f32 v210, v210
    v_rcp_f32 v211, v211
    v_rcp_f32 v212, v212
    v_rcp_f32 v213, v213
    v_rcp_f32 v214, v214
    v_rcp_f32 v215, v215
    v_mul_f32 v92, v92, v208
    v_mul_f32 v93, v93, v209
    v_mul_f32 v94, v94, v210
    v_mul_f32 v95, v95, v211
    v_mul_f32 v108, v108, v212
    v_mul_f32 v109, v109, v213
    v_mul_f32 v110, v110, v214
    v_mul_f32 v111, v111, v215
    v_cvt_pk_bf16_f32 v204, v92, v93
    v_cvt_pk_bf16_f32 v206, v108, v109
    v_cvt_pk_bf16_f32 v205, v94, v95
    v_cvt_pk_bf16_f32 v207, v110, v111
    s_add_u32 s53, s0, 409600
    v_permlane16_swap_b32 v204, v206
    v_permlane16_swap_b32 v205, v207
    buffer_store_dwordx4 v[204:207], v248, s[40:43], s53 offen sc1
WS29:
    v_fmac_f32 v112, v228, v152
    v_fmac_f32 v113, v228, v153
    v_fmac_f32 v114, v228, v154
    v_fmac_f32 v115, v228, v155
    v_fmac_f32 v116, v230, v152
    v_fmac_f32 v117, v230, v153
    v_fmac_f32 v118, v230, v154
    v_fmac_f32 v119, v230, v155
    v_mul_f32 v208, v229, v112
    v_mul_f32 v209, v229, v113
    v_mul_f32 v210, v229, v114
    v_mul_f32 v211, v229, v115
    v_mul_f32 v212, v231, v116
    v_mul_f32 v213, v231, v117
    v_mul_f32 v214, v231, v118
    v_mul_f32 v215, v231, v119
    v_exp_f32 v208, v208
    v_exp_f32 v209, v209
    v_exp_f32 v210, v210
    v_exp_f32 v211, v211
    v_exp_f32 v212, v212
    v_exp_f32 v213, v213
    v_exp_f32 v214, v214
    v_exp_f32 v215, v215
    v_fma_f32 v208, v208, v157, v157
    v_fma_f32 v209, v209, v157, v157
    v_fma_f32 v210, v210, v157, v157
    v_fma_f32 v211, v211, v157, v157
    v_fma_f32 v212, v212, v159, v159
    v_fma_f32 v213, v213, v159, v159
    v_fma_f32 v214, v214, v159, v159
    v_fma_f32 v215, v215, v159, v159
    v_rcp_f32 v208, v208
    v_rcp_f32 v209, v209
    v_rcp_f32 v210, v210
    v_rcp_f32 v211, v211
    v_rcp_f32 v212, v212
    v_rcp_f32 v213, v213
    v_rcp_f32 v214, v214
    v_rcp_f32 v215, v215
    v_mul_f32 v112, v112, v208
    v_mul_f32 v113, v113, v209
    v_mul_f32 v114, v114, v210
    v_mul_f32 v115, v115, v211
    v_mul_f32 v116, v116, v212
    v_mul_f32 v117, v117, v213
    v_mul_f32 v118, v118, v214
    v_mul_f32 v119, v119, v215
    v_cvt_pk_bf16_f32 v164, v112, v113
    v_cvt_pk_bf16_f32 v166, v116, v117
    v_cvt_pk_bf16_f32 v165, v114, v115
    v_cvt_pk_bf16_f32 v167, v118, v119
    s_add_u32 s53, s1, 0
    v_permlane16_swap_b32 v164, v166
    v_permlane16_swap_b32 v165, v167
    buffer_store_dwordx4 v[164:167], v249, s[40:43], s53 offen sc1
WS30:
    v_fmac_f32 v120, v232, v152
    v_fmac_f32 v121, v232, v153
    v_fmac_f32 v122, v232, v154
    v_fmac_f32 v123, v232, v155
    v_fmac_f32 v124, v234, v152
    v_fmac_f32 v125, v234, v153
    v_fmac_f32 v126, v234, v154
    v_fmac_f32 v127, v234, v155
    v_mul_f32 v208, v233, v120
    v_mul_f32 v209, v233, v121
    v_mul_f32 v210, v233, v122
    v_mul_f32 v211, v233, v123
    v_mul_f32 v212, v235, v124
    v_mul_f32 v213, v235, v125
    v_mul_f32 v214, v235, v126
    v_mul_f32 v215, v235, v127
    v_exp_f32 v208, v208
    v_exp_f32 v209, v209
    v_exp_f32 v210, v210
    v_exp_f32 v211, v211
    v_exp_f32 v212, v212
    v_exp_f32 v213, v213
    v_exp_f32 v214, v214
    v_exp_f32 v215, v215
    v_fma_f32 v208, v208, v161, v161
    v_fma_f32 v209, v209, v161, v161
    v_fma_f32 v210, v210, v161, v161
    v_fma_f32 v211, v211, v161, v161
    v_fma_f32 v212, v212, v163, v163
    v_fma_f32 v213, v213, v163, v163
    v_fma_f32 v214, v214, v163, v163
    v_fma_f32 v215, v215, v163, v163
    v_rcp_f32 v208, v208
    v_rcp_f32 v209, v209
    v_rcp_f32 v210, v210
    v_rcp_f32 v211, v211
    v_rcp_f32 v212, v212
    v_rcp_f32 v213, v213
    v_rcp_f32 v214, v214
    v_rcp_f32 v215, v215
    v_mul_f32 v120, v120, v208
    v_mul_f32 v121, v121, v209
    v_mul_f32 v122, v122, v210
    v_mul_f32 v123, v123, v211
    v_mul_f32 v124, v124, v212
    v_mul_f32 v125, v125, v213
    v_mul_f32 v126, v126, v214
    v_mul_f32 v127, v127, v215
    v_cvt_pk_bf16_f32 v168, v120, v121
    v_cvt_pk_bf16_f32 v170, v124, v125
    v_cvt_pk_bf16_f32 v169, v122, v123
    v_cvt_pk_bf16_f32 v171, v126, v127
    s_add_u32 s53, s1, 229376
    v_permlane16_swap_b32 v168, v170
    v_permlane16_swap_b32 v169, v171
    buffer_store_dwordx4 v[168:171], v249, s[40:43], s53 offen sc1
WS31:
    s_waitcnt vmcnt(6) lgkmcnt(0)
    s_mov_b32 exec_hi, 0
    buffer_store_dword v15, v5, s[40:43], s52 offen offset:0 sc1
    s_mov_b64 exec, -1
    s_add_u32 s52, s52, 131072
    v_mov_b32 v6, v156
    v_mov_b32 v7, v224
    v_mov_b32 v8, v158
    v_mov_b32 v9, v225
    v_mov_b32 v10, v160
    v_mov_b32 v11, v226
    v_mov_b32 v12, v162
    v_mov_b32 v13, v227
    v_mov_b32 v16, 0
    v_mov_b32 v17, 0
    v_pk_mov_b32 v[18:19], v[16:17], v[16:17]
    v_pk_mov_b32 v[20:21], v[16:17], v[16:17]
    v_pk_mov_b32 v[22:23], v[16:17], v[16:17]
    v_pk_mov_b32 v[24:25], v[16:17], v[16:17]
    v_pk_mov_b32 v[26:27], v[16:17], v[16:17]
    v_pk_mov_b32 v[28:29], v[16:17], v[16:17]
    v_pk_mov_b32 v[30:31], v[16:17], v[16:17]
    v_pk_mov_b32 v[32:33], v[16:17], v[16:17]
    v_pk_mov_b32 v[34:35], v[16:17], v[16:17]
    v_pk_mov_b32 v[36:37], v[16:17], v[16:17]
    v_pk_mov_b32 v[38:39], v[16:17], v[16:17]
    v_pk_mov_b32 v[40:41], v[16:17], v[16:17]
    v_pk_mov_b32 v[42:43], v[16:17], v[16:17]
    v_pk_mov_b32 v[44:45], v[16:17], v[16:17]
    v_pk_mov_b32 v[46:47], v[16:17], v[16:17]
    v_pk_mov_b32 v[48:49], v[16:17], v[16:17]
    v_pk_mov_b32 v[50:51], v[16:17], v[16:17]
    v_pk_mov_b32 v[52:53], v[16:17], v[16:17]
    v_pk_mov_b32 v[54:55], v[16:17], v[16:17]
    v_pk_mov_b32 v[56:57], v[16:17], v[16:17]
    v_pk_mov_b32 v[58:59], v[16:17], v[16:17]
    v_pk_mov_b32 v[60:61], v[16:17], v[16:17]
    v_pk_mov_b32 v[62:63], v[16:17], v[16:17]
    v_pk_mov_b32 v[64:65], v[16:17], v[16:17]
    v_pk_mov_b32 v[66:67], v[16:17], v[16:17]
    v_pk_mov_b32 v[68:69], v[16:17], v[16:17]
    v_pk_mov_b32 v[70:71], v[16:17], v[16:17]
    v_pk_mov_b32 v[72:73], v[16:17], v[16:17]
    v_pk_mov_b32 v[74:75], v[16:17], v[16:17]
    v_pk_mov_b32 v[76:77], v[16:17], v[16:17]
    v_pk_mov_b32 v[78:79], v[16:17], v[16:17]
    v_pk_mov_b32 v[80:81], v[16:17], v[16:17]
    v_pk_mov_b32 v[82:83], v[16:17], v[16:17]
    v_pk_mov_b32 v[84:85], v[16:17], v[16:17]
    v_pk_mov_b32 v[86:87], v[16:17], v[16:17]
    v_pk_mov_b32 v[88:89], v[16:17], v[16:17]
    v_pk_mov_b32 v[90:91], v[16:17], v[16:17]
    v_pk_mov_b32 v[92:93], v[16:17], v[16:17]
    v_pk_mov_b32 v[94:95], v[16:17], v[16:17]
    v_pk_mov_b32 v[96:97], v[16:17], v[16:17]
    v_pk_mov_b32 v[98:99], v[16:17], v[16:17]
    v_pk_mov_b32 v[100:101], v[16:17], v[16:17]
    v_pk_mov_b32 v[102:103], v[16:17], v[16:17]
    v_pk_mov_b32 v[104:105], v[16:17], v[16:17]
    v_pk_mov_b32 v[106:107], v[16:17], v[16:17]
    v_pk_mov_b32 v[108:109], v[16:17], v[16:17]
    v_pk_mov_b32 v[110:111], v[16:17], v[16:17]
    v_pk_mov_b32 v[112:113], v[16:17], v[16:17]
    v_pk_mov_b32 v[114:115], v[16:17], v[16:17]
    v_pk_mov_b32 v[116:117], v[16:17], v[16:17]
    v_pk_mov_b32 v[118:119], v[16:17], v[16:17]
    v_pk_mov_b32 v[120:121], v[16:17], v[16:17]
    v_pk_mov_b32 v[122:123], v[16:17], v[16:17]
    v_pk_mov_b32 v[124:125], v[16:17], v[16:17]
    v_pk_mov_b32 v[126:127], v[16:17], v[16:17]
    v_pk_mov_b32 v[128:129], v[16:17], v[16:17]
    v_pk_mov_b32 v[130:131], v[16:17], v[16:17]
    v_pk_mov_b32 v[132:133], v[16:17], v[16:17]
    v_pk_mov_b32 v[134:135], v[16:17], v[16:17]
    v_pk_mov_b32 v[136:137], v[16:17], v[16:17]
    v_pk_mov_b32 v[138:139], v[16:17], v[16:17]
    v_pk_mov_b32 v[140:141], v[16:17], v[16:17]
    v_pk_mov_b32 v[142:143], v[16:17], v[16:17]
    s_mov_b32 s53, 0
    s_mov_b32 s55, 0
    s_mov_b32 s56, 3
    s_mov_b32 s60, 49152
    s_mov_b32 s61, -98304
    s_mov_b32 s57, 32768
    s_mov_b32 s58, 65536
    s_mov_b32 s59, 98304
    s_barrier
    ds_read_b64_tr_b16 v[208:209], v241 offset:0
    ds_read_b64_tr_b16 v[210:211], v241 offset:512
    ds_read_b64_tr_b16 v[212:213], v241 offset:4096
    ds_read_b64_tr_b16 v[214:215], v241 offset:4608
    ds_read_b128 v[144:147], v240 offset:0
    ds_read_b128 v[148:151], v240 offset:1024
    ds_read_b128 v[152:155], v240 offset:2048
    ds_read_b128 v[156:159], v240 offset:3072
    ds_read_b128 v[160:163], v240 offset:4096
    ds_read_b128 v[164:167], v240 offset:5120
    ds_read_b128 v[168:171], v240 offset:6144
    ds_read_b128 v[172:175], v240 offset:7168
    ds_read_b64_tr_b16 v[216:217], v242 offset:0
    ds_read_b64_tr_b16 v[218:219], v242 offset:512
    ds_read_b64_tr_b16 v[220:221], v242 offset:4096
    ds_read_b64_tr_b16 v[222:223], v242 offset:4608
    ds_read_b64_tr_b16 v[224:225], v241 offset:8192
    ds_read_b64_tr_b16 v[226:227], v241 offset:8704
    ds_read_b64_tr_b16 v[228:229], v241 offset:12288
    ds_read_b64_tr_b16 v[230:231], v241 offset:12800
    ds_write_b128 v244, v[192:195] offset:0
    ds_write_b128 v244, v[196:199] offset:2048
    ds_write_b128 v244, v[200:203] offset:4096
    ds_write_b128 v244, v[204:207] offset:6144
    s_branch C_l2
C_a1:
    s_waitcnt vmcnt(0)
    s_mov_b32 exec_hi, 0
    buffer_store_dword v15, v5, s[40:43], s52 offen offset:0 sc1
    s_mov_b64 exec, -1
C_l2:
    s_waitcnt lgkmcnt(15)
    v_mfma_f32_16x16x32_bf16 v[16:19], v[208:211], v[144:147], v[16:19]
    ds_read_b64_tr_b16 v[232:233], v242 offset:8192
    s_waitcnt lgkmcnt(15)
    v_mfma_f32_16x16x32_bf16 v[16:19], v[212:215], v[148:151], v[16:19]
    ds_read_b64_tr_b16 v[234:235], v242 offset:8704
    s_waitcnt lgkmcnt(15)
    v_mfma_f32_16x16x32_bf16 v[24:27], v[208:211], v[152:155], v[24:27]
    ds_read_b64_tr_b16 v[236:237], v242 offset:12288
    s_waitcnt lgkmcnt(15)
    v_mfma_f32_16x16x32_bf16 v[24:27], v[212:215], v[156:159], v[24:27]
    ds_read_b64_tr_b16 v[238:239], v242 offset:12800
    s_waitcnt lgkmcnt(15)
    v_mfma_f32_16x16x32_bf16 v[32:35], v[208:211], v[160:163], v[32:35]
    s_waitcnt lgkmcnt(14)
    v_mfma_f32_16x16x32_bf16 v[32:35], v[212:215], v[164:167], v[32:35]
    s_waitcnt lgkmcnt(13)
    v_mfma_f32_16x16x32_bf16 v[40:43], v[208:211], v[168:171], v[40:43]
    s_waitcnt lgkmcnt(12)
    v_mfma_f32_16x16x32_bf16 v[40:43], v[212:215], v[172:175], v[40:43]
    s_waitcnt lgkmcnt(10)
    v_mfma_f32_16x16x32_bf16 v[44:47], v[216:219], v[168:171], v[44:47]
    ds_read_b64_tr_b16 v[208:209], v241 offset:16384
    s_waitcnt lgkmcnt(9)
    v_mfma_f32_16x16x32_bf16 v[44:47], v[220:223], v[172:175], v[44:47]
    ds_read_b64_tr_b16 v[210:211], v241 offset:16896
    v_mfma_f32_16x16x32_bf16 v[36:39], v[216:219], v[160:163], v[36:39]
    ds_read_b64_tr_b16 v[212:213], v241 offset:20480
    v_mfma_f32_16x16x32_bf16 v[36:39], v[220:223], v[164:167], v[36:39]
    ds_read_b64_tr_b16 v[214:215], v241 offset:20992
    v_mfma_f32_16x16x32_bf16 v[28:31], v[216:219], v[152:155], v[28:31]
    v_mfma_f32_16x16x32_bf16 v[28:31], v[220:223], v[156:159], v[28:31]
    v_mfma_f32_16x16x32_bf16 v[20:23], v[216:219], v[144:147], v[20:23]
    v_mfma_f32_16x16x32_bf16 v[20:23], v[220:223], v[148:151], v[20:23]
    s_waitcnt lgkmcnt(10)
    v_mfma_f32_16x16x32_bf16 v[48:51], v[224:227], v[144:147], v[48:51]
    ds_read_b64_tr_b16 v[216:217], v242 offset:16384
    s_waitcnt lgkmcnt(9)
    v_mfma_f32_16x16x32_bf16 v[48:51], v[228:231], v[148:151], v[48:51]
    ds_read_b64_tr_b16 v[218:219], v242 offset:16896
    v_mfma_f32_16x16x32_bf16 v[56:59], v[224:227], v[152:155], v[56:59]
    ds_read_b64_tr_b16 v[220:221], v242 offset:20480
    v_mfma_f32_16x16x32_bf16 v[56:59], v[228:231], v[156:159], v[56:59]
    ds_read_b64_tr_b16 v[222:223], v242 offset:20992
    v_mfma_f32_16x16x32_bf16 v[64:67], v[224:227], v[160:163], v[64:67]
    v_mfma_f32_16x16x32_bf16 v[64:67], v[228:231], v[164:167], v[64:67]
    v_mfma_f32_16x16x32_bf16 v[72:75], v[224:227], v[168:171], v[72:75]
    v_mfma_f32_16x16x32_bf16 v[72:75], v[228:231], v[172:175], v[72:75]
    s_waitcnt lgkmcnt(10)
    v_mfma_f32_16x16x32_bf16 v[76:79], v[232:235], v[168:171], v[76:79]
    ds_read_b64_tr_b16 v[224:225], v241 offset:24576
    s_waitcnt lgkmcnt(9)
    v_mfma_f32_16x16x32_bf16 v[76:79], v[236:239], v[172:175], v[76:79]
    ds_read_b64_tr_b16 v[226:227], v241 offset:25088
    v_mfma_f32_16x16x32_bf16 v[68:71], v[232:235], v[160:163], v[68:71]
    ds_read_b64_tr_b16 v[228:229], v241 offset:28672
    v_mfma_f32_16x16x32_bf16 v[68:71], v[236:239], v[164:167], v[68:71]
    ds_read_b64_tr_b16 v[230:231], v241 offset:29184
    v_mfma_f32_16x16x32_bf16 v[60:63], v[232:235], v[152:155], v[60:63]
    s_add_u32 s53, s53, 1
    s_cmp_eq_u32 s53, s56
    s_cselect_b32 s54, s61, s60
    s_cselect_b32 s53, 0, s53
    v_add_u32 v240, s54, v240
    v_mfma_f32_16x16x32_bf16 v[60:63], v[236:239], v[156:159], v[60:63]
    v_mfma_f32_16x16x32_bf16 v[52:55], v[232:235], v[144:147], v[52:55]
    v_mfma_f32_16x16x32_bf16 v[52:55], v[236:239], v[148:151], v[52:55]
    s_waitcnt lgkmcnt(10)
    v_mfma_f32_16x16x32_bf16 v[80:83], v[208:211], v[144:147], v[80:83]
    ds_read_b64_tr_b16 v[232:233], v242 offset:24576
    s_waitcnt lgkmcnt(9)
    v_mfma_f32_16x16x32_bf16 v[80:83], v[212:215], v[148:151], v[80:83]
    ds_read_b64_tr_b16 v[234:235], v242 offset:25088
    v_mfma_f32_16x16x32_bf16 v[88:91], v[208:211], v[152:155], v[88:91]
    ds_read_b64_tr_b16 v[236:237], v242 offset:28672
    v_mfma_f32_16x16x32_bf16 v[88:91], v[212:215], v[156:159], v[88:91]
    ds_read_b64_tr_b16 v[238:239], v242 offset:29184
    v_mfma_f32_16x16x32_bf16 v[96:99], v[208:211], v[160:163], v[96:99]
    v_add_u32 v241, s54, v241
    v_add_u32 v242, s54, v242
    v_mfma_f32_16x16x32_bf16 v[96:99], v[212:215], v[164:167], v[96:99]
    v_mfma_f32_16x16x32_bf16 v[104:107], v[208:211], v[168:171], v[104:107]
    v_mfma_f32_16x16x32_bf16 v[104:107], v[212:215], v[172:175], v[104:107]
    s_waitcnt lgkmcnt(0)
    s_barrier
    v_mfma_f32_16x16x32_bf16 v[108:111], v[216:219], v[168:171], v[108:111]
    ds_read_b64_tr_b16 v[208:209], v241 offset:0
    v_mfma_f32_16x16x32_bf16 v[108:111], v[220:223], v[172:175], v[108:111]
    ds_read_b64_tr_b16 v[210:211], v241 offset:512
    v_mfma_f32_16x16x32_bf16 v[100:103], v[216:219], v[160:163], v[100:103]
    ds_read_b64_tr_b16 v[212:213], v241 offset:4096
    v_mfma_f32_16x16x32_bf16 v[100:103], v[220:223], v[164:167], v[100:103]
    ds_read_b64_tr_b16 v[214:215], v241 offset:4608
    v_mfma_f32_16x16x32_bf16 v[92:95], v[216:219], v[152:155], v[92:95]
    ds_read_b128 v[176:179], v240 offset:0
    v_mfma_f32_16x16x32_bf16 v[92:95], v[220:223], v[156:159], v[92:95]
    ds_read_b128 v[180:183], v240 offset:1024
    v_mfma_f32_16x16x32_bf16 v[84:87], v[216:219], v[144:147], v[84:87]
    ds_read_b128 v[184:187], v240 offset:2048
    v_mfma_f32_16x16x32_bf16 v[84:87], v[220:223], v[148:151], v[84:87]
    ds_read_b128 v[188:191], v240 offset:3072
    v_mfma_f32_16x16x32_bf16 v[112:115], v[224:227], v[144:147], v[112:115]
    ds_read_b128 v[192:195], v240 offset:4096
    v_mfma_f32_16x16x32_bf16 v[112:115], v[228:231], v[148:151], v[112:115]
    ds_read_b128 v[196:199], v240 offset:5120
    v_mfma_f32_16x16x32_bf16 v[120:123], v[224:227], v[152:155], v[120:123]
    ds_read_b128 v[200:203], v240 offset:6144
    v_mfma_f32_16x16x32_bf16 v[120:123], v[228:231], v[156:159], v[120:123]
    ds_read_b128 v[204:207], v240 offset:7168
    v_mfma_f32_16x16x32_bf16 v[128:131], v[224:227], v[160:163], v[128:131]
    ds_read_b64_tr_b16 v[216:217], v242 offset:0
    v_mfma_f32_16x16x32_bf16 v[128:131], v[228:231], v[164:167], v[128:131]
    ds_read_b64_tr_b16 v[218:219], v242 offset:512
    v_mfma_f32_16x16x32_bf16 v[136:139], v[224:227], v[168:171], v[136:139]
    ds_read_b64_tr_b16 v[220:221], v242 offset:4096
    v_mfma_f32_16x16x32_bf16 v[136:139], v[228:231], v[172:175], v[136:139]
    ds_read_b64_tr_b16 v[222:223], v242 offset:4608
    v_mfma_f32_16x16x32_bf16 v[140:143], v[232:235], v[168:171], v[140:143]
    ds_read_b64_tr_b16 v[224:225], v241 offset:8192
    v_mfma_f32_16x16x32_bf16 v[140:143], v[236:239], v[172:175], v[140:143]
    ds_read_b64_tr_b16 v[226:227], v241 offset:8704
    v_mfma_f32_16x16x32_bf16 v[132:135], v[232:235], v[160:163], v[132:135]
    ds_read_b64_tr_b16 v[228:229], v241 offset:12288
    v_mfma_f32_16x16x32_bf16 v[132:135], v[236:239], v[164:167], v[132:135]
    ds_read_b64_tr_b16 v[230:231], v241 offset:12800
    v_mfma_f32_16x16x32_bf16 v[124:127], v[232:235], v[152:155], v[124:127]
    s_cmp_eq_u32 s55, 6
    v_mfma_f32_16x16x32_bf16 v[124:127], v[236:239], v[156:159], v[124:127]
    v_mfma_f32_16x16x32_bf16 v[116:119], v[232:235], v[144:147], v[116:119]
    v_mfma_f32_16x16x32_bf16 v[116:119], v[236:239], v[148:151], v[116:119]
    s_cbranch_scc1 C_tail
    s_waitcnt lgkmcnt(15)
    v_mfma_f32_16x16x32_bf16 v[16:19], v[208:211], v[176:179], v[16:19]
    ds_read_b64_tr_b16 v[232:233], v242 offset:8192
    s_waitcnt lgkmcnt(15)
    v_mfma_f32_16x16x32_bf16 v[16:19], v[212:215], v[180:183], v[16:19]
    ds_read_b64_tr_b16 v[234:235], v242 offset:8704
    s_waitcnt lgkmcnt(15)
    v_mfma_f32_16x16x32_bf16 v[24:27], v[208:211], v[184:187], v[24:27]
    ds_read_b64_tr_b16 v[236:237], v242 offset:12288
    s_waitcnt lgkmcnt(15)
    v_mfma_f32_16x16x32_bf16 v[24:27], v[212:215], v[188:191], v[24:27]
    ds_read_b64_tr_b16 v[238:239], v242 offset:12800
    s_waitcnt lgkmcnt(15)
    v_mfma_f32_16x16x32_bf16 v[32:35], v[208:211], v[192:195], v[32:35]
    s_waitcnt lgkmcnt(14)
    v_mfma_f32_16x16x32_bf16 v[32:35], v[212:215], v[196:199], v[32:35]
    s_waitcnt lgkmcnt(13)
    v_mfma_f32_16x16x32_bf16 v[40:43], v[208:211], v[200:203], v[40:43]
    s_waitcnt lgkmcnt(12)
    v_mfma_f32_16x16x32_bf16 v[40:43], v[212:215], v[204:207], v[40:43]
    s_waitcnt lgkmcnt(10)
    v_mfma_f32_16x16x32_bf16 v[44:47], v[216:219], v[200:203], v[44:47]
    ds_read_b64_tr_b16 v[208:209], v241 offset:16384
    s_waitcnt lgkmcnt(9)
    v_mfma_f32_16x16x32_bf16 v[44:47], v[220:223], v[204:207], v[44:47]
    ds_read_b64_tr_b16 v[210:211], v241 offset:16896
    v_mfma_f32_16x16x32_bf16 v[36:39], v[216:219], v[192:195], v[36:39]
    ds_read_b64_tr_b16 v[212:213], v241 offset:20480
    v_mfma_f32_16x16x32_bf16 v[36:39], v[220:223], v[196:199], v[36:39]
    ds_read_b64_tr_b16 v[214:215], v241 offset:20992
    v_mfma_f32_16x16x32_bf16 v[28:31], v[216:219], v[184:187], v[28:31]
    v_mfma_f32_16x16x32_bf16 v[28:31], v[220:223], v[188:191], v[28:31]
    v_mfma_f32_16x16x32_bf16 v[20:23], v[216:219], v[176:179], v[20:23]
    v_mfma_f32_16x16x32_bf16 v[20:23], v[220:223], v[180:183], v[20:23]
    s_waitcnt lgkmcnt(10)
    v_mfma_f32_16x16x32_bf16 v[48:51], v[224:227], v[176:179], v[48:51]
    ds_read_b64_tr_b16 v[216:217], v242 offset:16384
    s_waitcnt lgkmcnt(9)
    v_mfma_f32_16x16x32_bf16 v[48:51], v[228:231], v[180:183], v[48:51]
    ds_read_b64_tr_b16 v[218:219], v242 offset:16896
    v_mfma_f32_16x16x32_bf16 v[56:59], v[224:227], v[184:187], v[56:59]
    ds_read_b64_tr_b16 v[220:221], v242 offset:20480
    v_mfma_f32_16x16x32_bf16 v[56:59], v[228:231], v[188:191], v[56:59]
    ds_read_b64_tr_b16 v[222:223], v242 offset:20992
    v_mfma_f32_16x16x32_bf16 v[64:67], v[224:227], v[192:195], v[64:67]
    v_mfma_f32_16x16x32_bf16 v[64:67], v[228:231], v[196:199], v[64:67]
    v_mfma_f32_16x16x32_bf16 v[72:75], v[224:227], v[200:203], v[72:75]
    v_mfma_f32_16x16x32_bf16 v[72:75], v[228:231], v[204:207], v[72:75]
    s_waitcnt lgkmcnt(10)
    v_mfma_f32_16x16x32_bf16 v[76:79], v[232:235], v[200:203], v[76:79]
    ds_read_b64_tr_b16 v[224:225], v241 offset:24576
    s_waitcnt lgkmcnt(9)
    v_mfma_f32_16x16x32_bf16 v[76:79], v[236:239], v[204:207], v[76:79]
    ds_read_b64_tr_b16 v[226:227], v241 offset:25088
    v_mfma_f32_16x16x32_bf16 v[68:71], v[232:235], v[192:195], v[68:71]
    ds_read_b64_tr_b16 v[228:229], v241 offset:28672
    v_mfma_f32_16x16x32_bf16 v[68:71], v[236:239], v[196:199], v[68:71]
    ds_read_b64_tr_b16 v[230:231], v241 offset:29184
    v_mfma_f32_16x16x32_bf16 v[60:63], v[232:235], v[184:187], v[60:63]
    s_add_u32 s53, s53, 1
    s_cmp_eq_u32 s53, s56
    s_cselect_b32 s54, s61, s60
    s_cselect_b32 s53, 0, s53
    v_add_u32 v240, s54, v240
    v_mfma_f32_16x16x32_bf16 v[60:63], v[236:239], v[188:191], v[60:63]
    v_mfma_f32_16x16x32_bf16 v[52:55], v[232:235], v[176:179], v[52:55]
    v_mfma_f32_16x16x32_bf16 v[52:55], v[236:239], v[180:183], v[52:55]
    s_waitcnt lgkmcnt(10)
    v_mfma_f32_16x16x32_bf16 v[80:83], v[208:211], v[176:179], v[80:83]
    ds_read_b64_tr_b16 v[232:233], v242 offset:24576
    s_waitcnt lgkmcnt(9)
    v_mfma_f32_16x16x32_bf16 v[80:83], v[212:215], v[180:183], v[80:83]
    ds_read_b64_tr_b16 v[234:235], v242 offset:25088
    v_mfma_f32_16x16x32_bf16 v[88:91], v[208:211], v[184:187], v[88:91]
    ds_read_b64_tr_b16 v[236:237], v242 offset:28672
    v_mfma_f32_16x16x32_bf16 v[88:91], v[212:215], v[188:191], v[88:91]
    ds_read_b64_tr_b16 v[238:239], v242 offset:29184
    v_mfma_f32_16x16x32_bf16 v[96:99], v[208:211], v[192:195], v[96:99]
    v_add_u32 v241, s54, v241
    v_add_u32 v242, s54, v242
    v_mfma_f32_16x16x32_bf16 v[96:99], v[212:215], v[196:199], v[96:99]
    v_mfma_f32_16x16x32_bf16 v[104:107], v[208:211], v[200:203], v[104:107]
    v_mfma_f32_16x16x32_bf16 v[104:107], v[212:215], v[204:207], v[104:107]
    s_waitcnt lgkmcnt(0)
    s_barrier
    v_mfma_f32_16x16x32_bf16 v[108:111], v[216:219], v[200:203], v[108:111]
    ds_read_b64_tr_b16 v[208:209], v241 offset:0
    v_mfma_f32_16x16x32_bf16 v[108:111], v[220:223], v[204:207], v[108:111]
    ds_read_b64_tr_b16 v[210:211], v241 offset:512
    v_mfma_f32_16x16x32_bf16 v[100:103], v[216:219], v[192:195], v[100:103]
    ds_read_b64_tr_b16 v[212:213], v241 offset:4096
    v_mfma_f32_16x16x32_bf16 v[100:103], v[220:223], v[196:199], v[100:103]
    ds_read_b64_tr_b16 v[214:215], v241 offset:4608
    v_mfma_f32_16x16x32_bf16 v[92:95], v[216:219], v[184:187], v[92:95]
    ds_read_b128 v[144:147], v240 offset:0
    v_mfma_f32_16x16x32_bf16 v[92:95], v[220:223], v[188:191], v[92:95]
    ds_read_b128 v[148:151], v240 offset:1024
    v_mfma_f32_16x16x32_bf16 v[84:87], v[216:219], v[176:179], v[84:87]
    ds_read_b128 v[152:155], v240 offset:2048
    v_mfma_f32_16x16x32_bf16 v[84:87], v[220:223], v[180:183], v[84:87]
    ds_read_b128 v[156:159], v240 offset:3072
    v_mfma_f32_16x16x32_bf16 v[112:115], v[224:227], v[176:179], v[112:115]
    ds_read_b128 v[160:163], v240 offset:4096
    v_mfma_f32_16x16x32_bf16 v[112:115], v[228:231], v[180:183], v[112:115]
    ds_read_b128 v[164:167], v240 offset:5120
    v_mfma_f32_16x16x32_bf16 v[120:123], v[224:227], v[184:187], v[120:123]
    ds_read_b128 v[168:171], v240 offset:6144
    v_mfma_f32_16x16x32_bf16 v[120:123], v[228:231], v[188:191], v[120:123]
    ds_read_b128 v[172:175], v240 offset:7168
    v_mfma_f32_16x16x32_bf16 v[128:131], v[224:227], v[192:195], v[128:131]
    ds_read_b64_tr_b16 v[216:217], v242 offset:0
    v_mfma_f32_16x16x32_bf16 v[128:131], v[228:231], v[196:199], v[128:131]
    ds_read_b64_tr_b16 v[218:219], v242 offset:512
    v_mfma_f32_16x16x32_bf16 v[136:139], v[224:227], v[200:203], v[136:139]
    ds_read_b64_tr_b16 v[220:221], v242 offset:4096
    v_mfma_f32_16x16x32_bf16 v[136:139], v[228:231], v[204:207], v[136:139]
    ds_read_b64_tr_b16 v[222:223], v242 offset:4608
    v_mfma_f32_16x16x32_bf16 v[140:143], v[232:235], v[200:203], v[140:143]
    ds_read_b64_tr_b16 v[224:225], v241 offset:8192
    v_mfma_f32_16x16x32_bf16 v[140:143], v[236:239], v[204:207], v[140:143]
    ds_read_b64_tr_b16 v[226:227], v241 offset:8704
    v_mfma_f32_16x16x32_bf16 v[132:135], v[232:235], v[192:195], v[132:135]
    ds_read_b64_tr_b16 v[228:229], v241 offset:12288
    v_mfma_f32_16x16x32_bf16 v[132:135], v[236:239], v[196:199], v[132:135]
    ds_read_b64_tr_b16 v[230:231], v241 offset:12800
    v_mfma_f32_16x16x32_bf16 v[124:127], v[232:235], v[184:187], v[124:127]
    s_add_u32 s55, s55, 1
    s_cmp_eq_u32 s55, 1
    v_mfma_f32_16x16x32_bf16 v[124:127], v[236:239], v[188:191], v[124:127]
    v_mfma_f32_16x16x32_bf16 v[116:119], v[232:235], v[176:179], v[116:119]
    v_mfma_f32_16x16x32_bf16 v[116:119], v[236:239], v[180:183], v[116:119]
    s_cbranch_scc1 C_a1
    s_branch C_l2
C_tail:
    s_mov_b32 s53, 0
    s_mov_b32 s56, 4
    s_mov_b32 s60, 24576
    s_mov_b32 s61, -73728
    v_readfirstlane_b32 s21, v15
    s_waitcnt lgkmcnt(0)
    ds_read_b64_tr_b16 v[144:145], v241 offset:0
    ds_read_b64_tr_b16 v[146:147], v241 offset:512
    ds_read_b128 v[176:179], v240 offset:0
    ds_read_b64_tr_b16 v[148:149], v242 offset:0
    ds_read_b64_tr_b16 v[150:151], v242 offset:512
    ds_read_b128 v[180:183], v240 offset:2048
    ds_read_b128 v[184:187], v240 offset:4096
    ds_read_b128 v[188:191], v240 offset:6144
    v_mov_b32 v208, v6
    v_mov_b32 v209, v7
    v_mov_b32 v210, v8
    v_mov_b32 v211, v9
    v_mov_b32 v212, v10
    v_mov_b32 v213, v11
    v_mov_b32 v214, v12
    v_mov_b32 v215, v13
    s_xor_b32 s50, s6, 1
    s_mul_i32 s50, s50, 3
    s_add_u32 s50, s50, 0
    s_lshl_b32 s50, s50, 2
    s_add_u32 s50, s50, s3
    s_lshl_b32 s50, s50, 12
    s_add_u32 s50, s50, 33554432
    v_cvt_pk_bf16_f32 v48, v48, v49
    v_cvt_pk_bf16_f32 v49, v50, v51
    v_cvt_pk_bf16_f32 v50, v52, v53
    v_cvt_pk_bf16_f32 v51, v54, v55
    buffer_store_dwordx4 v[48:51], v248, s[40:43], s50 offen offset:0 sc1
    v_cvt_pk_bf16_f32 v52, v56, v57
    v_cvt_pk_bf16_f32 v53, v58, v59
    v_cvt_pk_bf16_f32 v54, v60, v61
    v_cvt_pk_bf16_f32 v55, v62, v63
    buffer_store_dwordx4 v[52:55], v248, s[40:43], s50 offen offset:1024 sc1
    v_cvt_pk_bf16_f32 v56, v64, v65
    v_cvt_pk_bf16_f32 v57, v66, v67
    v_cvt_pk_bf16_f32 v58, v68, v69
    v_cvt_pk_bf16_f32 v59, v70, v71
    buffer_store_dwordx4 v[56:59], v248, s[40:43], s50 offen offset:2048 sc1
    v_cvt_pk_bf16_f32 v60, v72, v73
    v_cvt_pk_bf16_f32 v61, v74, v75
    v_cvt_pk_bf16_f32 v62, v76, v77
    v_cvt_pk_bf16_f32 v63, v78, v79
    buffer_store_dwordx4 v[60:63], v248, s[40:43], s50 offen offset:3072 sc1
    s_xor_b32 s50, s6, 2
    s_mul_i32 s50, s50, 3
    s_add_u32 s50, s50, 1
    s_lshl_b32 s50, s50, 2
    s_add_u32 s50, s50, s3
    s_lshl_b32 s50, s50, 12
    s_add_u32 s50, s50, 33554432
    v_cvt_pk_bf16_f32 v80, v80, v81
    v_cvt_pk_bf16_f32 v81, v82, v83
    v_cvt_pk_bf16_f32 v82, v84, v85
    v_cvt_pk_bf16_f32 v83, v86, v87
    buffer_store_dwordx4 v[80:83], v248, s[40:43], s50 offen offset:0 sc1
    v_cvt_pk_bf16_f32 v84, v88, v89
    v_cvt_pk_bf16_f32 v85, v90, v91
    v_cvt_pk_bf16_f32 v86, v92, v93
    v_cvt_pk_bf16_f32 v87, v94, v95
    buffer_store_dwordx4 v[84:87], v248, s[40:43], s50 offen offset:1024 sc1
    s_waitcnt lgkmcnt(0)
    v_mfma_f32_16x16x32_bf16 v[16:19], v[144:147], v[176:179], v[16:19]
    ds_read_b64_tr_b16 v[192:193], v241 offset:4096
    ds_read_b64_tr_b16 v[194:195], v241 offset:4608
    v_mfma_f32_16x16x32_bf16 v[20:23], v[148:151], v[176:179], v[20:23]
    ds_read_b128 v[224:227], v240 offset:1024
    v_mfma_f32_16x16x32_bf16 v[28:31], v[148:151], v[180:183], v[28:31]
    ds_read_b64_tr_b16 v[196:197], v242 offset:4096
    ds_read_b64_tr_b16 v[198:199], v242 offset:4608
    v_mfma_f32_16x16x32_bf16 v[24:27], v[144:147], v[180:183], v[24:27]
    ds_read_b128 v[228:231], v240 offset:3072
    v_mfma_f32_16x16x32_bf16 v[32:35], v[144:147], v[184:187], v[32:35]
    ds_read_b128 v[232:235], v240 offset:5120
    v_mfma_f32_16x16x32_bf16 v[36:39], v[148:151], v[184:187], v[36:39]
    ds_read_b128 v[236:239], v240 offset:7168
    v_mfma_f32_16x16x32_bf16 v[44:47], v[148:151], v[188:191], v[44:47]
    s_add_u32 s53, s53, 1
    s_cmp_eq_u32 s53, s56
    s_cselect_b32 s54, s61, s60
    s_cselect_b32 s53, 0, s53
    v_add_u32 v240, s54, v240
    v_mfma_f32_16x16x32_bf16 v[40:43], v[144:147], v[188:191], v[40:43]
    v_add_u32 v241, s54, v241
    v_add_u32 v242, s54, v242
    v_cvt_pk_bf16_f32 v88, v96, v97
    v_cvt_pk_bf16_f32 v89, v98, v99
    v_cvt_pk_bf16_f32 v90, v100, v101
    v_cvt_pk_bf16_f32 v91, v102, v103
    buffer_store_dwordx4 v[88:91], v248, s[40:43], s50 offen offset:2048 sc1
    v_cvt_pk_bf16_f32 v92, v104, v105
    v_cvt_pk_bf16_f32 v93, v106, v107
    v_cvt_pk_bf16_f32 v94, v108, v109
    v_cvt_pk_bf16_f32 v95, v110, v111
    buffer_store_dwordx4 v[92:95], v248, s[40:43], s50 offen offset:3072 sc1
    s_waitcnt lgkmcnt(0)
    s_barrier
    v_mfma_f32_16x16x32_bf16 v[16:19], v[192:195], v[224:227], v[16:19]
    ds_read_b64_tr_b16 v[144:145], v241 offset:0
    ds_read_b64_tr_b16 v[146:147], v241 offset:512
    v_mfma_f32_16x16x32_bf16 v[20:23], v[196:199], v[224:227], v[20:23]
    ds_read_b128 v[176:179], v240 offset:0
    v_mfma_f32_16x16x32_bf16 v[28:31], v[196:199], v[228:231], v[28:31]
    ds_read_b64_tr_b16 v[148:149], v242 offset:0
    ds_read_b64_tr_b16 v[150:151], v242 offset:512
    v_mfma_f32_16x16x32_bf16 v[24:27], v[192:195], v[228:231], v[24:27]
    ds_read_b128 v[180:183], v240 offset:2048
    v_mfma_f32_16x16x32_bf16 v[32:35], v[192:195], v[232:235], v[32:35]
    ds_read_b128 v[184:187], v240 offset:4096
    v_mfma_f32_16x16x32_bf16 v[36:39], v[196:199], v[232:235], v[36:39]
    ds_read_b128 v[188:191], v240 offset:6144
    v_mfma_f32_16x16x32_bf16 v[44:47], v[196:199], v[236:239], v[44:47]
    v_mfma_f32_16x16x32_bf16 v[40:43], v[192:195], v[236:239], v[40:43]
    s_xor_b32 s50, s6, 3
    s_mul_i32 s50, s50, 3
    s_add_u32 s50, s50, 2
    s_lshl_b32 s50, s50, 2
    s_add_u32 s50, s50, s3
    s_lshl_b32 s50, s50, 12
    s_add_u32 s50, s50, 33554432
    v_cvt_pk_bf16_f32 v112, v112, v113
    v_cvt_pk_bf16_f32 v113, v114, v115
    v_cvt_pk_bf16_f32 v114, v116, v117
    v_cvt_pk_bf16_f32 v115, v118, v119
    buffer_store_dwordx4 v[112:115], v248, s[40:43], s50 offen offset:0 sc1
    v_cvt_pk_bf16_f32 v116, v120, v121
    v_cvt_pk_bf16_f32 v117, v122, v123
    v_cvt_pk_bf16_f32 v118, v124, v125
    v_cvt_pk_bf16_f32 v119, v126, v127
    buffer_store_dwordx4 v[116:119], v248, s[40:43], s50 offen offset:1024 sc1
    s_waitcnt lgkmcnt(0)
    v_mfma_f32_16x16x32_bf16 v[16:19], v[144:147], v[176:179], v[16:19]
    ds_read_b64_tr_b16 v[192:193], v241 offset:4096
    ds_read_b64_tr_b16 v[194:195], v241 offset:4608
    v_mfma_f32_16x16x32_bf16 v[20:23], v[148:151], v[176:179], v[20:23]
    ds_read_b128 v[224:227], v240 offset:1024
    v_mfma_f32_16x16x32_bf16 v[28:31], v[148:151], v[180:183], v[28:31]
    ds_read_b64_tr_b16 v[196:197], v242 offset:4096
    ds_read_b64_tr_b16 v[198:199], v242 offset:4608
    v_mfma_f32_16x16x32_bf16 v[24:27], v[144:147], v[180:183], v[24:27]
    ds_read_b128 v[228:231], v240 offset:3072
    v_mfma_f32_16x16x32_bf16 v[32:35], v[144:147], v[184:187], v[32:35]
    ds_read_b128 v[232:235], v240 offset:5120
    v_mfma_f32_16x16x32_bf16 v[36:39], v[148:151], v[184:187], v[36:39]
    ds_read_b128 v[236:239], v240 offset:7168
    v_mfma_f32_16x16x32_bf16 v[44:47], v[148:151], v[188:191], v[44:47]
    s_add_u32 s53, s53, 1
    s_cmp_eq_u32 s53, s56
    s_cselect_b32 s54, s61, s60
    s_cselect_b32 s53, 0, s53
    v_add_u32 v240, s54, v240
    v_mfma_f32_16x16x32_bf16 v[40:43], v[144:147], v[188:191], v[40:43]
    v_add_u32 v241, s54, v241
    v_add_u32 v242, s54, v242
    v_cvt_pk_bf16_f32 v120, v128, v129
    v_cvt_pk_bf16_f32 v121, v130, v131
    v_cvt_pk_bf16_f32 v122, v132, v133
    v_cvt_pk_bf16_f32 v123, v134, v135
    buffer_store_dwordx4 v[120:123], v248, s[40:43], s50 offen offset:2048 sc1
    v_cvt_pk_bf16_f32 v124, v136, v137
    v_cvt_pk_bf16_f32 v125, v138, v139
    v_cvt_pk_bf16_f32 v126, v140, v141
    v_cvt_pk_bf16_f32 v127, v142, v143
    buffer_store_dwordx4 v[124:127], v248, s[40:43], s50 offen offset:3072 sc1
    s_waitcnt lgkmcnt(0)
    s_barrier
    v_mfma_f32_16x16x32_bf16 v[16:19], v[192:195], v[224:227], v[16:19]
    ds_read_b64_tr_b16 v[144:145], v241 offset:0
    ds_read_b64_tr_b16 v[146:147], v241 offset:512
    v_mfma_f32_16x16x32_bf16 v[20:23], v[196:199], v[224:227], v[20:23]
    ds_read_b128 v[176:179], v240 offset:0
    v_mfma_f32_16x16x32_bf16 v[28:31], v[196:199], v[228:231], v[28:31]
    ds_read_b64_tr_b16 v[148:149], v242 offset:0
    ds_read_b64_tr_b16 v[150:151], v242 offset:512
    v_mfma_f32_16x16x32_bf16 v[24:27], v[192:195], v[228:231], v[24:27]
    ds_read_b128 v[180:183], v240 offset:2048
    v_mfma_f32_16x16x32_bf16 v[32:35], v[192:195], v[232:235], v[32:35]
    ds_read_b128 v[184:187], v240 offset:4096
    v_mfma_f32_16x16x32_bf16 v[36:39], v[196:199], v[232:235], v[36:39]
    ds_read_b128 v[188:191], v240 offset:6144
    v_mfma_f32_16x16x32_bf16 v[44:47], v[196:199], v[236:239], v[44:47]
    v_mfma_f32_16x16x32_bf16 v[40:43], v[192:195], v[236:239], v[40:43]
    s_add_u32 s52, s62, 32505856
    s_waitcnt vmcnt(8)
    s_mov_b32 exec_hi, 0
    buffer_store_dword v15, v5, s[40:43], s52 offen offset:0 sc1
    s_mov_b64 exec, -1
    s_waitcnt lgkmcnt(0)
    v_mfma_f32_16x16x32_bf16 v[16:19], v[144:147], v[176:179], v[16:19]
    ds_read_b64_tr_b16 v[192:193], v241 offset:4096
    ds_read_b64_tr_b16 v[194:195], v241 offset:4608
    v_mfma_f32_16x16x32_bf16 v[20:23], v[148:151], v[176:179], v[20:23]
    ds_read_b128 v[224:227], v240 offset:1024
    v_mfma_f32_16x16x32_bf16 v[28:31], v[148:151], v[180:183], v[28:31]
    ds_read_b64_tr_b16 v[196:197], v242 offset:4096
    ds_read_b64_tr_b16 v[198:199], v242 offset:4608
    v_mfma_f32_16x16x32_bf16 v[24:27], v[144:147], v[180:183], v[24:27]
    ds_read_b128 v[228:231], v240 offset:3072
    v_mfma_f32_16x16x32_bf16 v[32:35], v[144:147], v[184:187], v[32:35]
    ds_read_b128 v[232:235], v240 offset:5120
    v_mfma_f32_16x16x32_bf16 v[36:39], v[148:151], v[184:187], v[36:39]
    ds_read_b128 v[236:239], v240 offset:7168
    v_mfma_f32_16x16x32_bf16 v[44:47], v[148:151], v[188:191], v[44:47]
    s_add_u32 s53, s53, 1
    s_cmp_eq_u32 s53, s56
    s_cselect_b32 s54, s61, s60
    s_cselect_b32 s53, 0, s53
    v_add_u32 v240, s54, v240
    v_mfma_f32_16x16x32_bf16 v[40:43], v[144:147], v[188:191], v[40:43]
    v_add_u32 v241, s54, v241
    v_add_u32 v242, s54, v242
    v_add_u32 v247, 1, v2
    v_xor_b32 v247, s6, v247
    v_lshlrev_b32 v247, 9, v247
    v_lshl_add_u32 v247, v2, 17, v247
    s_lshl_b32 s51, s3, 7
    s_add_u32 s51, s51, 32505856
    s_add_u32 s52, s62, 32636928
    s_waitcnt vmcnt(5)
    s_mov_b32 exec_hi, 0
    buffer_store_dword v15, v5, s[40:43], s52 offen offset:0 sc1
    s_mov_b64 exec, -1
    s_waitcnt lgkmcnt(0)
    s_barrier
    v_mfma_f32_16x16x32_bf16 v[16:19], v[192:195], v[224:227], v[16:19]
    ds_read_b64_tr_b16 v[144:145], v241 offset:0
    ds_read_b64_tr_b16 v[146:147], v241 offset:512
    v_mfma_f32_16x16x32_bf16 v[20:23], v[196:199], v[224:227], v[20:23]
    ds_read_b128 v[176:179], v240 offset:0
    v_mfma_f32_16x16x32_bf16 v[28:31], v[196:199], v[228:231], v[28:31]
    ds_read_b64_tr_b16 v[148:149], v242 offset:0
    ds_read_b64_tr_b16 v[150:151], v242 offset:512
    v_mfma_f32_16x16x32_bf16 v[24:27], v[192:195], v[228:231], v[24:27]
    ds_read_b128 v[180:183], v240 offset:2048
    v_mfma_f32_16x16x32_bf16 v[32:35], v[192:195], v[232:235], v[32:35]
    ds_read_b128 v[184:187], v240 offset:4096
    v_mfma_f32_16x16x32_bf16 v[36:39], v[196:199], v[232:235], v[36:39]
    ds_read_b128 v[188:191], v240 offset:6144
    v_mfma_f32_16x16x32_bf16 v[44:47], v[196:199], v[236:239], v[44:47]
    v_mfma_f32_16x16x32_bf16 v[40:43], v[192:195], v[236:239], v[40:43]
    s_waitcnt lgkmcnt(0)
    v_mfma_f32_16x16x32_bf16 v[16:19], v[144:147], v[176:179], v[16:19]
    ds_read_b64_tr_b16 v[192:193], v241 offset:4096
    ds_read_b64_tr_b16 v[194:195], v241 offset:4608
    v_mfma_f32_16x16x32_bf16 v[20:23], v[148:151], v[176:179], v[20:23]
    ds_read_b128 v[224:227], v240 offset:1024
    v_mfma_f32_16x16x32_bf16 v[28:31], v[148:151], v[180:183], v[28:31]
    ds_read_b64_tr_b16 v[196:197], v242 offset:4096
    ds_read_b64_tr_b16 v[198:199], v242 offset:4608
    v_mfma_f32_16x16x32_bf16 v[24:27], v[144:147], v[180:183], v[24:27]
    ds_read_b128 v[228:231], v240 offset:3072
    v_mfma_f32_16x16x32_bf16 v[32:35], v[144:147], v[184:187], v[32:35]
    ds_read_b128 v[232:235], v240 offset:5120
    v_mfma_f32_16x16x32_bf16 v[36:39], v[148:151], v[184:187], v[36:39]
    ds_read_b128 v[236:239], v240 offset:7168
    v_mfma_f32_16x16x32_bf16 v[44:47], v[148:151], v[188:191], v[44:47]
    s_add_u32 s53, s53, 1
    s_cmp_eq_u32 s53, s56
    s_cselect_b32 s54, s61, s60
    s_cselect_b32 s53, 0, s53
    v_add_u32 v240, s54, v240
    v_mfma_f32_16x16x32_bf16 v[40:43], v[144:147], v[188:191], v[40:43]
    v_add_u32 v241, s54, v241
    v_add_u32 v242, s54, v242
    s_waitcnt lgkmcnt(0)
    s_barrier
    v_mfma_f32_16x16x32_bf16 v[16:19], v[192:195], v[224:227], v[16:19]
    v_mfma_f32_16x16x32_bf16 v[20:23], v[196:199], v[224:227], v[20:23]
    v_mfma_f32_16x16x32_bf16 v[28:31], v[196:199], v[228:231], v[28:31]
    v_mfma_f32_16x16x32_bf16 v[24:27], v[192:195], v[228:231], v[24:27]
    v_mfma_f32_16x16x32_bf16 v[32:35], v[192:195], v[232:235], v[32:35]
    v_mfma_f32_16x16x32_bf16 v[36:39], v[196:199], v[232:235], v[36:39]
    v_mfma_f32_16x16x32_bf16 v[44:47], v[196:199], v[236:239], v[44:47]
    v_mfma_f32_16x16x32_bf16 v[40:43], v[192:195], v[236:239], v[40:43]
    ds_read_b64 v[128:129], v250 offset:0
    ds_read_b64 v[130:131], v251 offset:0
    ds_read_b64 v[132:133], v250 offset:2048
    ds_read_b64 v[134:135], v251 offset:2048
    ds_read_b64 v[136:137], v250 offset:4096
    ds_read_b64 v[138:139], v251 offset:4096
    ds_read_b64 v[140:141], v250 offset:6144
    ds_read_b64 v[142:143], v251 offset:6144
    v_mov_b32 v243, 0
    v_not_b32 v243, v15
    s_mov_b64 exec, 3
    buffer_load_dword v243, v247, s[40:43], s51 offen sc1
    s_mov_b64 exec, -1
    s_add_u32 s52, s62, 32768000
    s_waitcnt vmcnt(3)
    s_mov_b32 exec_hi, 0
    buffer_store_dword v15, v5, s[40:43], s52 offen offset:0 sc1
    s_mov_b64 exec, -1
    s_mul_i32 s50, s6, 12
    s_add_u32 s50, s50, s3
    s_lshl_b32 s50, s50, 12
    s_add_u32 s50, s50, 33554432
    v_lshrrev_b32 v6, 2, v2
    v_lshlrev_b32 v10, 8, v6
    v_and_b32 v6, 7, v6
    s_lshl_b32 s52, s48, 2
    v_xor_b32 v6, s52, v6
    v_and_b32 v11, 3, v2
    v_lshl_add_u32 v10, v11, 3, v10
    s_lshl_b32 s52, s49, 13
    s_add_u32 s52, s52, 147456
    v_add_u32 v10, s52, v10
    v_xor_b32 v11, 0, v6
    v_lshl_add_u32 v12, v11, 5, v10
    v_xor_b32 v11, 1, v6
    v_lshl_add_u32 v13, v11, 5, v10
    v_xor_b32 v11, 2, v6
    v_lshl_add_u32 v245, v11, 5, v10
    v_xor_b32 v11, 3, v6
    v_lshl_add_u32 v246, v11, 5, v10
    s_waitcnt vmcnt(1)
    s_mov_b64 exec, 7
    s_mov_b32 s63, 0
PL32p:
    v_cmp_ne_u32 vcc, s21, v243
    s_and_b32 s55, vcc_lo, 4
    s_and_b64 vcc, vcc, 3
    s_cbranch_vccz PL32d
    s_sleep 1
    buffer_load_dword v243, v247, s[40:43], s51 offen sc1
    s_add_u32 s63, s63, 1
    s_cmp_lt_u32 s63, 262144
    s_waitcnt vmcnt(0)
    s_cbranch_scc1 PL32p
PL32d:
    s_mov_b64 exec, -1
    buffer_load_dwordx4 v[80:83], v248, s[40:43], s50 offen offset:0 sc1
    buffer_load_dwordx4 v[84:87], v248, s[40:43], s50 offen offset:1024 sc1
    buffer_load_dwordx4 v[88:91], v248, s[40:43], s50 offen offset:2048 sc1
    buffer_load_dwordx4 v[92:95], v248, s[40:43], s50 offen offset:3072 sc1
    s_add_u32 s50, s50, 16384
    buffer_load_dwordx4 v[96:99], v248, s[40:43], s50 offen offset:0 sc1
    buffer_load_dwordx4 v[100:103], v248, s[40:43], s50 offen offset:1024 sc1
    buffer_load_dwordx4 v[104:107], v248, s[40:43], s50 offen offset:2048 sc1
    buffer_load_dwordx4 v[108:111], v248, s[40:43], s50 offen offset:3072 sc1
    s_add_u32 s50, s50, 16384
    s_cmp_lg_u32 s55, 0
    s_cbranch_scc1 C_n3
    buffer_load_dwordx4 v[112:115], v248, s[40:43], s50 offen offset:0 sc1
    buffer_load_dwordx4 v[116:119], v248, s[40:43], s50 offen offset:1024 sc1
    buffer_load_dwordx4 v[120:123], v248, s[40:43], s50 offen offset:2048 sc1
    buffer_load_dwordx4 v[124:127], v248, s[40:43], s50 offen offset:3072 sc1
    s_add_u32 s50, s50, 16384
C_n3:
    s_waitcnt lgkmcnt(0)
    v_lshlrev_b32 v152, 16, v128
    v_and_b32 v153, 0xffff0000, v128
    v_lshlrev_b32 v154, 16, v129
    v_and_b32 v155, 0xffff0000, v129
    v_sub_f32 v48, v152, v208
    v_sub_f32 v49, v153, v208
    v_sub_f32 v50, v154, v208
    v_sub_f32 v51, v155, v208
    v_cvt_pk_bf16_f32 v128, v48, v49
    v_cvt_pk_bf16_f32 v129, v50, v51
    v_lshlrev_b32 v48, 16, v128
    v_and_b32 v49, 0xffff0000, v128
    v_lshlrev_b32 v50, 16, v129
    v_and_b32 v51, 0xffff0000, v129
    v_mul_f32 v48, v48, v209
    v_mul_f32 v49, v49, v209
    v_mul_f32 v50, v50, v209
    v_mul_f32 v51, v51, v209
    v_lshlrev_b32 v156, 16, v130
    v_and_b32 v157, 0xffff0000, v130
    v_lshlrev_b32 v158, 16, v131
    v_and_b32 v159, 0xffff0000, v131
    v_sub_f32 v52, v156, v208
    v_sub_f32 v53, v157, v208
    v_sub_f32 v54, v158, v208
    v_sub_f32 v55, v159, v208
    v_cvt_pk_bf16_f32 v130, v52, v53
    v_cvt_pk_bf16_f32 v131, v54, v55
    v_lshlrev_b32 v52, 16, v130
    v_and_b32 v53, 0xffff0000, v130
    v_lshlrev_b32 v54, 16, v131
    v_and_b32 v55, 0xffff0000, v131
    v_mul_f32 v52, v52, v209
    v_mul_f32 v53, v53, v209
    v_mul_f32 v54, v54, v209
    v_mul_f32 v55, v55, v209
    v_lshlrev_b32 v160, 16, v132
    v_and_b32 v161, 0xffff0000, v132
    v_lshlrev_b32 v162, 16, v133
    v_and_b32 v163, 0xffff0000, v133
    v_sub_f32 v56, v160, v210
    v_sub_f32 v57, v161, v210
    v_sub_f32 v58, v162, v210
    v_sub_f32 v59, v163, v210
    v_cvt_pk_bf16_f32 v132, v56, v57
    v_cvt_pk_bf16_f32 v133, v58, v59
    v_lshlrev_b32 v56, 16, v132
    v_and_b32 v57, 0xffff0000, v132
    v_lshlrev_b32 v58, 16, v133
    v_and_b32 v59, 0xffff0000, v133
    v_mul_f32 v56, v56, v211
    v_mul_f32 v57, v57, v211
    v_mul_f32 v58, v58, v211
    v_mul_f32 v59, v59, v211
    s_cmp_eq_u32 s55, 0
    s_cbranch_scc1 C_s1
    s_mov_b64 exec, 4
    buffer_load_dword v243, v247, s[40:43], s51 offen sc1
    s_mov_b64 exec, -1
C_s1:
    v_lshlrev_b32 v164, 16, v134
    v_and_b32 v165, 0xffff0000, v134
    v_lshlrev_b32 v166, 16, v135
    v_and_b32 v167, 0xffff0000, v135
    v_sub_f32 v60, v164, v210
    v_sub_f32 v61, v165, v210
    v_sub_f32 v62, v166, v210
    v_sub_f32 v63, v167, v210
    v_cvt_pk_bf16_f32 v134, v60, v61
    v_cvt_pk_bf16_f32 v135, v62, v63
    v_lshlrev_b32 v60, 16, v134
    v_and_b32 v61, 0xffff0000, v134
    v_lshlrev_b32 v62, 16, v135
    v_and_b32 v63, 0xffff0000, v135
    v_mul_f32 v60, v60, v211
    v_mul_f32 v61, v61, v211
    v_mul_f32 v62, v62, v211
    v_mul_f32 v63, v63, v211
    v_lshlrev_b32 v168, 16, v136
    v_and_b32 v169, 0xffff0000, v136
    v_lshlrev_b32 v170, 16, v137
    v_and_b32 v171, 0xffff0000, v137
    v_sub_f32 v64, v168, v212
    v_sub_f32 v65, v169, v212
    v_sub_f32 v66, v170, v212
    v_sub_f32 v67, v171, v212
    v_cvt_pk_bf16_f32 v136, v64, v65
    v_cvt_pk_bf16_f32 v137, v66, v67
    v_lshlrev_b32 v64, 16, v136
    v_and_b32 v65, 0xffff0000, v136
    v_lshlrev_b32 v66, 16, v137
    v_and_b32 v67, 0xffff0000, v137
    v_mul_f32 v64, v64, v213
    v_mul_f32 v65, v65, v213
    v_mul_f32 v66, v66, v213
    v_mul_f32 v67, v67, v213
    v_lshlrev_b32 v172, 16, v138
    v_and_b32 v173, 0xffff0000, v138
    v_lshlrev_b32 v174, 16, v139
    v_and_b32 v175, 0xffff0000, v139
    v_sub_f32 v68, v172, v212
    v_sub_f32 v69, v173, v212
    v_sub_f32 v70, v174, v212
    v_sub_f32 v71, v175, v212
    v_cvt_pk_bf16_f32 v138, v68, v69
    v_cvt_pk_bf16_f32 v139, v70, v71
    v_lshlrev_b32 v68, 16, v138
    v_and_b32 v69, 0xffff0000, v138
    v_lshlrev_b32 v70, 16, v139
    v_and_b32 v71, 0xffff0000, v139
    v_mul_f32 v68, v68, v213
    v_mul_f32 v69, v69, v213
    v_mul_f32 v70, v70, v213
    v_mul_f32 v71, v71, v213
    v_lshlrev_b32 v200, 16, v140
    v_and_b32 v201, 0xffff0000, v140
    v_lshlrev_b32 v202, 16, v141
    v_and_b32 v203, 0xffff0000, v141
    v_sub_f32 v72, v200, v214
    v_sub_f32 v73, v201, v214
    v_sub_f32 v74, v202, v214
    v_sub_f32 v75, v203, v214
    v_cvt_pk_bf16_f32 v140, v72, v73
    v_cvt_pk_bf16_f32 v141, v74, v75
    v_lshlrev_b32 v72, 16, v140
    v_and_b32 v73, 0xffff0000, v140
    v_lshlrev_b32 v74, 16, v141
    v_and_b32 v75, 0xffff0000, v141
    v_mul_f32 v72, v72, v215
    v_mul_f32 v73, v73, v215
    v_mul_f32 v74, v74, v215
    v_mul_f32 v75, v75, v215
    v_lshlrev_b32 v204, 16, v142
    v_and_b32 v205, 0xffff0000, v142
    v_lshlrev_b32 v206, 16, v143
    v_and_b32 v207, 0xffff0000, v143
    v_sub_f32 v76, v204, v214
    v_sub_f32 v77, v205, v214
    v_sub_f32 v78, v206, v214
    v_sub_f32 v79, v207, v214
    v_cvt_pk_bf16_f32 v142, v76, v77
    v_cvt_pk_bf16_f32 v143, v78, v79
    v_lshlrev_b32 v76, 16, v142
    v_and_b32 v77, 0xffff0000, v142
    v_lshlrev_b32 v78, 16, v143
    v_and_b32 v79, 0xffff0000, v143
    v_mul_f32 v76, v76, v215
    v_mul_f32 v77, v77, v215
    v_mul_f32 v78, v78, v215
    v_mul_f32 v79, v79, v215
    ds_read_b64_tr_b16 v[128:129], v12 offset:0
    ds_read_b64_tr_b16 v[130:131], v12 offset:4096
    ds_read_b64_tr_b16 v[132:133], v13 offset:0
    ds_read_b64_tr_b16 v[134:135], v13 offset:4096
    ds_read_b64_tr_b16 v[136:137], v245 offset:0
    ds_read_b64_tr_b16 v[138:139], v245 offset:4096
    ds_read_b64_tr_b16 v[140:141], v246 offset:0
    ds_read_b64_tr_b16 v[142:143], v246 offset:4096
    s_lshl_b32 s52, s3, 12
    v_lshrrev_b32 v10, 1, v3
    v_and_b32 v10, 3, v10
    v_lshrrev_b32 v6, 1, v4
    v_xor_b32 v10, v10, v6
    v_lshlrev_b32 v6, 6, v3
    v_add_u32 v6, s52, v6
    v_and_b32 v7, 1, v4
    v_lshl_add_u32 v6, v7, 3, v6
    v_lshl_add_u32 v8, v10, 4, v6
    v_xor_b32 v10, 2, v10
    v_lshl_add_u32 v9, v10, 4, v6
    v_lshrrev_b32 v10, 3, v2
    v_xor_b32 v10, v10, v2
    v_and_b32 v10, 3, v10
    v_lshrrev_b32 v6, 2, v2
    v_lshlrev_b32 v6, 6, v6
    v_lshl_add_u32 v6, v10, 4, v6
    v_add_u32 v7, s52, v6
    s_mov_b32 s36, s26
    s_and_b32 s37, s27, 0xffff
    s_mov_b32 s38, 4194304
    s_mov_b32 s39, 0x20000
    s_cmp_eq_u32 s55, 0
    s_cbranch_scc1 C_s2
    s_waitcnt vmcnt(0)
    s_mov_b64 exec, 4
    s_mov_b32 s63, 0
PL33p:
    v_cmp_ne_u32 vcc, s21, v243
    s_cbranch_vccz PL33d
    s_sleep 1
    buffer_load_dword v243, v247, s[40:43], s51 offen sc1
    s_add_u32 s63, s63, 1
    s_cmp_lt_u32 s63, 262144
    s_waitcnt vmcnt(0)
    s_cbranch_scc1 PL33p
PL33d:
    s_mov_b64 exec, -1
    buffer_load_dwordx4 v[112:115], v248, s[40:43], s50 offen offset:0 sc1
    buffer_load_dwordx4 v[116:119], v248, s[40:43], s50 offen offset:1024 sc1
    buffer_load_dwordx4 v[120:123], v248, s[40:43], s50 offen offset:2048 sc1
    buffer_load_dwordx4 v[124:127], v248, s[40:43], s50 offen offset:3072 sc1
    s_add_u32 s50, s50, 16384
C_s2:
    s_waitcnt lgkmcnt(0)
    v_lshlrev_b32 v216, 16, v128
    v_and_b32 v217, 0xffff0000, v128
    v_lshlrev_b32 v218, 16, v129
    v_and_b32 v219, 0xffff0000, v129
    v_fmac_f32 v152, v48, v216
    v_fmac_f32 v153, v49, v217
    v_fmac_f32 v154, v50, v218
    v_fmac_f32 v155, v51, v219
    v_lshlrev_b32 v220, 16, v130
    v_and_b32 v221, 0xffff0000, v130
    v_lshlrev_b32 v222, 16, v131
    v_and_b32 v223, 0xffff0000, v131
    v_fmac_f32 v156, v52, v220
    v_fmac_f32 v157, v53, v221
    v_fmac_f32 v158, v54, v222
    v_fmac_f32 v159, v55, v223
    v_lshlrev_b32 v216, 16, v132
    v_and_b32 v217, 0xffff0000, v132
    v_lshlrev_b32 v218, 16, v133
    v_and_b32 v219, 0xffff0000, v133
    v_fmac_f32 v160, v56, v216
    v_fmac_f32 v161, v57, v217
    v_fmac_f32 v162, v58, v218
    v_fmac_f32 v163, v59, v219
    v_lshlrev_b32 v220, 16, v134
    v_and_b32 v221, 0xffff0000, v134
    v_lshlrev_b32 v222, 16, v135
    v_and_b32 v223, 0xffff0000, v135
    v_fmac_f32 v164, v60, v220
    v_fmac_f32 v165, v61, v221
    v_fmac_f32 v166, v62, v222
    v_fmac_f32 v167, v63, v223
    v_lshlrev_b32 v216, 16, v136
    v_and_b32 v217, 0xffff0000, v136
    v_lshlrev_b32 v218, 16, v137
    v_and_b32 v219, 0xffff0000, v137
    v_fmac_f32 v168, v64, v216
    v_fmac_f32 v169, v65, v217
    v_fmac_f32 v170, v66, v218
    v_fmac_f32 v171, v67, v219
    v_lshlrev_b32 v220, 16, v138
    v_and_b32 v221, 0xffff0000, v138
    v_lshlrev_b32 v222, 16, v139
    v_and_b32 v223, 0xffff0000, v139
    v_fmac_f32 v172, v68, v220
    v_fmac_f32 v173, v69, v221
    v_fmac_f32 v174, v70, v222
    v_fmac_f32 v175, v71, v223
    v_lshlrev_b32 v216, 16, v140
    v_and_b32 v217, 0xffff0000, v140
    v_lshlrev_b32 v218, 16, v141
    v_and_b32 v219, 0xffff0000, v141
    v_fmac_f32 v200, v72, v216
    v_fmac_f32 v201, v73, v217
    v_fmac_f32 v202, v74, v218
    v_fmac_f32 v203, v75, v219
    v_lshlrev_b32 v220, 16, v142
    v_and_b32 v221, 0xffff0000, v142
    v_lshlrev_b32 v222, 16, v143
    v_and_b32 v223, 0xffff0000, v143
    v_fmac_f32 v204, v76, v220
    v_fmac_f32 v205, v77, v221
    v_fmac_f32 v206, v78, v222
    v_fmac_f32 v207, v79, v223
    v_pk_add_f32 v[16:17], v[16:17], v[152:153]
    v_pk_add_f32 v[18:19], v[18:19], v[154:155]
    v_pk_add_f32 v[20:21], v[20:21], v[156:157]
    v_pk_add_f32 v[22:23], v[22:23], v[158:159]
    v_pk_add_f32 v[24:25], v[24:25], v[160:161]
    v_pk_add_f32 v[26:27], v[26:27], v[162:163]
    v_pk_add_f32 v[28:29], v[28:29], v[164:165]
    v_pk_add_f32 v[30:31], v[30:31], v[166:167]
    v_pk_add_f32 v[32:33], v[32:33], v[168:169]
    v_pk_add_f32 v[34:35], v[34:35], v[170:171]
    v_pk_add_f32 v[36:37], v[36:37], v[172:173]
    v_pk_add_f32 v[38:39], v[38:39], v[174:175]
    v_pk_add_f32 v[40:41], v[40:41], v[200:201]
    v_pk_add_f32 v[42:43], v[42:43], v[202:203]
    v_pk_add_f32 v[44:45], v[44:45], v[204:205]
    v_pk_add_f32 v[46:47], v[46:47], v[206:207]
    s_waitcnt vmcnt(4)
    v_lshlrev_b32 v176, 16, v80
    v_and_b32 v177, 0xffff0000, v80
    v_lshlrev_b32 v178, 16, v81
    v_and_b32 v179, 0xffff0000, v81
    v_lshlrev_b32 v180, 16, v82
    v_and_b32 v181, 0xffff0000, v82
    v_lshlrev_b32 v182, 16, v83
    v_and_b32 v183, 0xffff0000, v83
    v_lshlrev_b32 v184, 16, v84
    v_and_b32 v185, 0xffff0000, v84
    v_lshlrev_b32 v186, 16, v85
    v_and_b32 v187, 0xffff0000, v85
    v_lshlrev_b32 v188, 16, v86
    v_and_b32 v189, 0xffff0000, v86
    v_lshlrev_b32 v190, 16, v87
    v_and_b32 v191, 0xffff0000, v87
    v_lshlrev_b32 v192, 16, v88
    v_and_b32 v193, 0xffff0000, v88
    v_lshlrev_b32 v194, 16, v89
    v_and_b32 v195, 0xffff0000, v89
    v_lshlrev_b32 v196, 16, v90
    v_and_b32 v197, 0xffff0000, v90
    v_lshlrev_b32 v198, 16, v91
    v_and_b32 v199, 0xffff0000, v91
    v_lshlrev_b32 v224, 16, v92
    v_and_b32 v225, 0xffff0000, v92
    v_lshlrev_b32 v226, 16, v93
    v_and_b32 v227, 0xffff0000, v93
    v_lshlrev_b32 v228, 16, v94
    v_and_b32 v229, 0xffff0000, v94
    v_lshlrev_b32 v230, 16, v95
    v_and_b32 v231, 0xffff0000, v95
    v_pk_add_f32 v[16:17], v[16:17], v[176:177]
    v_pk_add_f32 v[18:19], v[18:19], v[178:179]
    v_pk_add_f32 v[20:21], v[20:21], v[180:181]
    v_pk_add_f32 v[22:23], v[22:23], v[182:183]
    v_pk_add_f32 v[24:25], v[24:25], v[184:185]
    v_pk_add_f32 v[26:27], v[26:27], v[186:187]
    v_pk_add_f32 v[28:29], v[28:29], v[188:189]
    v_pk_add_f32 v[30:31], v[30:31], v[190:191]
    v_pk_add_f32 v[32:33], v[32:33], v[192:193]
    v_pk_add_f32 v[34:35], v[34:35], v[194:195]
    v_pk_add_f32 v[36:37], v[36:37], v[196:197]
    v_pk_add_f32 v[38:39], v[38:39], v[198:199]
    v_pk_add_f32 v[40:41], v[40:41], v[224:225]
    v_pk_add_f32 v[42:43], v[42:43], v[226:227]
    v_pk_add_f32 v[44:45], v[44:45], v[228:229]
    v_pk_add_f32 v[46:47], v[46:47], v[230:231]
    v_lshlrev_b32 v176, 16, v96
    v_and_b32 v177, 0xffff0000, v96
    v_lshlrev_b32 v178, 16, v97
    v_and_b32 v179, 0xffff0000, v97
    v_lshlrev_b32 v180, 16, v98
    v_and_b32 v181, 0xffff0000, v98
    v_lshlrev_b32 v182, 16, v99
    v_and_b32 v183, 0xffff0000, v99
    v_lshlrev_b32 v184, 16, v100
    v_and_b32 v185, 0xffff0000, v100
    v_lshlrev_b32 v186, 16, v101
    v_and_b32 v187, 0xffff0000, v101
    v_lshlrev_b32 v188, 16, v102
    v_and_b32 v189, 0xffff0000, v102
    v_lshlrev_b32 v190, 16, v103
    v_and_b32 v191, 0xffff0000, v103
    v_lshlrev_b32 v192, 16, v104
    v_and_b32 v193, 0xffff0000, v104
    v_lshlrev_b32 v194, 16, v105
    v_and_b32 v195, 0xffff0000, v105
    v_lshlrev_b32 v196, 16, v106
    v_and_b32 v197, 0xffff0000, v106
    v_lshlrev_b32 v198, 16, v107
    v_and_b32 v199, 0xffff0000, v107
    v_lshlrev_b32 v224, 16, v108
    v_and_b32 v225, 0xffff0000, v108
    v_lshlrev_b32 v226, 16, v109
    v_and_b32 v227, 0xffff0000, v109
    v_lshlrev_b32 v228, 16, v110
    v_and_b32 v229, 0xffff0000, v110
    v_lshlrev_b32 v230, 16, v111
    v_and_b32 v231, 0xffff0000, v111
    v_pk_add_f32 v[16:17], v[16:17], v[176:177]
    v_pk_add_f32 v[18:19], v[18:19], v[178:179]
    v_pk_add_f32 v[20:21], v[20:21], v[180:181]
    v_pk_add_f32 v[22:23], v[22:23], v[182:183]
    v_pk_add_f32 v[24:25], v[24:25], v[184:185]
    v_pk_add_f32 v[26:27], v[26:27], v[186:187]
    v_pk_add_f32 v[28:29], v[28:29], v[188:189]
    v_pk_add_f32 v[30:31], v[30:31], v[190:191]
    v_pk_add_f32 v[32:33], v[32:33], v[192:193]
    v_pk_add_f32 v[34:35], v[34:35], v[194:195]
    v_pk_add_f32 v[36:37], v[36:37], v[196:197]
    v_pk_add_f32 v[38:39], v[38:39], v[198:199]
    v_pk_add_f32 v[40:41], v[40:41], v[224:225]
    v_pk_add_f32 v[42:43], v[42:43], v[226:227]
    v_pk_add_f32 v[44:45], v[44:45], v[228:229]
    v_pk_add_f32 v[46:47], v[46:47], v[230:231]
    s_waitcnt vmcnt(0)
    v_lshlrev_b32 v176, 16, v112
    v_and_b32 v177, 0xffff0000, v112
    v_lshlrev_b32 v178, 16, v113
    v_and_b32 v179, 0xffff0000, v113
    v_lshlrev_b32 v180, 16, v114
    v_and_b32 v181, 0xffff0000, v114
    v_lshlrev_b32 v182, 16, v115
    v_and_b32 v183, 0xffff0000, v115
    v_lshlrev_b32 v184, 16, v116
    v_and_b32 v185, 0xffff0000, v116
    v_lshlrev_b32 v186, 16, v117
    v_and_b32 v187, 0xffff0000, v117
    v_lshlrev_b32 v188, 16, v118
    v_and_b32 v189, 0xffff0000, v118
    v_lshlrev_b32 v190, 16, v119
    v_and_b32 v191, 0xffff0000, v119
    v_lshlrev_b32 v192, 16, v120
    v_and_b32 v193, 0xffff0000, v120
    v_lshlrev_b32 v194, 16, v121
    v_and_b32 v195, 0xffff0000, v121
    v_lshlrev_b32 v196, 16, v122
    v_and_b32 v197, 0xffff0000, v122
    v_lshlrev_b32 v198, 16, v123
    v_and_b32 v199, 0xffff0000, v123
    v_lshlrev_b32 v224, 16, v124
    v_and_b32 v225, 0xffff0000, v124
    v_lshlrev_b32 v226, 16, v125
    v_and_b32 v227, 0xffff0000, v125
    v_lshlrev_b32 v228, 16, v126
    v_and_b32 v229, 0xffff0000, v126
    v_lshlrev_b32 v230, 16, v127
    v_and_b32 v231, 0xffff0000, v127
    v_pk_add_f32 v[16:17], v[16:17], v[176:177]
    v_pk_add_f32 v[18:19], v[18:19], v[178:179]
    v_pk_add_f32 v[20:21], v[20:21], v[180:181]
    v_pk_add_f32 v[22:23], v[22:23], v[182:183]
    v_pk_add_f32 v[24:25], v[24:25], v[184:185]
    v_pk_add_f32 v[26:27], v[26:27], v[186:187]
    v_pk_add_f32 v[28:29], v[28:29], v[188:189]
    v_pk_add_f32 v[30:31], v[30:31], v[190:191]
    v_pk_add_f32 v[32:33], v[32:33], v[192:193]
    v_pk_add_f32 v[34:35], v[34:35], v[194:195]
    v_pk_add_f32 v[36:37], v[36:37], v[196:197]
    v_pk_add_f32 v[38:39], v[38:39], v[198:199]
    v_pk_add_f32 v[40:41], v[40:41], v[224:225]
    v_pk_add_f32 v[42:43], v[42:43], v[226:227]
    v_pk_add_f32 v[44:45], v[44:45], v[228:229]
    v_pk_add_f32 v[46:47], v[46:47], v[230:231]
    s_waitcnt lgkmcnt(0)
    v_cvt_pk_bf16_f32 v16, v16, v17
    v_cvt_pk_bf16_f32 v17, v18, v19
    ds_write_b64 v8, v[16:17] offset:0
    v_cvt_pk_bf16_f32 v20, v20, v21
    v_cvt_pk_bf16_f32 v21, v22, v23
    ds_write_b64 v9, v[20:21] offset:0
    ds_read_b128 v[80:83], v7 offset:0
    v_cvt_pk_bf16_f32 v24, v24, v25
    v_cvt_pk_bf16_f32 v25, v26, v27
    ds_write_b64 v8, v[24:25] offset:1024
    v_cvt_pk_bf16_f32 v28, v28, v29
    v_cvt_pk_bf16_f32 v29, v30, v31
    ds_write_b64 v9, v[28:29] offset:1024
    ds_read_b128 v[84:87], v7 offset:1024
    v_cvt_pk_bf16_f32 v32, v32, v33
    v_cvt_pk_bf16_f32 v33, v34, v35
    ds_write_b64 v8, v[32:33] offset:2048
    v_cvt_pk_bf16_f32 v36, v36, v37
    v_cvt_pk_bf16_f32 v37, v38, v39
    ds_write_b64 v9, v[36:37] offset:2048
    ds_read_b128 v[88:91], v7 offset:2048
    v_cvt_pk_bf16_f32 v40, v40, v41
    v_cvt_pk_bf16_f32 v41, v42, v43
    ds_write_b64 v8, v[40:41] offset:3072
    v_cvt_pk_bf16_f32 v44, v44, v45
    v_cvt_pk_bf16_f32 v45, v46, v47
    ds_write_b64 v9, v[44:45] offset:3072
    ds_read_b128 v[92:95], v7 offset:3072
    s_waitcnt lgkmcnt(9)
    buffer_store_dwordx4 v[80:83], v14, s[36:39], 0 offen sc1
    s_waitcnt lgkmcnt(6)
    buffer_store_dwordx4 v[84:87], v14, s[36:39], s57 offen sc1
    s_waitcnt lgkmcnt(3)
    buffer_store_dwordx4 v[88:91], v14, s[36:39], s58 offen sc1
    s_waitcnt lgkmcnt(0)
    buffer_store_dwordx4 v[92:95], v14, s[36:39], s59 offen sc1
    s_endpgm
K_end:
    s_endpgm
.section .rodata,"a"
.p2align 6
.amdhsa_kernel parallel_sum__ssm_conv_h3__dense_activation_silu__prompt_kernel
  .amdhsa_next_free_vgpr 256
  .amdhsa_next_free_sgpr 102
  .amdhsa_accum_offset 256
  .amdhsa_group_segment_fixed_size 0
  .amdhsa_kernarg_size 96
  .amdhsa_user_sgpr_count 2
  .amdhsa_user_sgpr_kernarg_segment_ptr 1
  .amdhsa_system_sgpr_workgroup_id_x 1
.end_amdhsa_kernel
```
